```python
import torch

def _softmax(x, axis=-1):
    return torch.softmax(x, dim=axis)
def _gelu(x):
    return torch.nn.functional.gelu(x, approximate="tanh")
def _silu(x):
    return torch.nn.functional.silu(x)
def _sigmoid(x):
    return torch.sigmoid(x)
def _layernorm(x, axis=-1, eps=1e-5):
    m = x.mean(dim=axis, keepdim=True)
    v = x.var(dim=axis, keepdim=True, unbiased=False)
    return (x - m) / torch.sqrt(v + eps)
def _scatter_add(tgt, idx, src, axis=0):
    return tgt.clone().index_add_(axis, idx, src)
def _segment_sum(src, seg, n):
    out = torch.zeros((n,) + src.shape[1:], dtype=src.dtype)
    return out.index_add_(0, seg, src)
def _pad(x, pw):
    flat = tuple(v for pair in reversed(pw) for v in pair)
    return torch.nn.functional.pad(x, flat)

kernel_name = 'parallel_sum__ssm_conv_s4__mixer_channel_mlp__prompt'

def setup_inputs():

    _w = (lambda a: (lambda t: t.to(torch.bfloat16) if t.is_floating_point() else t)(torch.as_tensor(a)))
    def _A_setup():
        B, L, D, N = 1, 2048, 448, 256
        A_re = -(lambda _x: torch.exp(torch.as_tensor(_x)))((lambda *s: torch.randn(*s, dtype=torch.bfloat16) * 3.2)(D, N))
        A_im = torch.pi * (lambda *s: torch.randn(*s, dtype=torch.bfloat16) * 0.05)(D, N)
        B_re = (lambda *s: torch.randn(*s, dtype=torch.bfloat16) * 0.1)(D, N)
        B_im = (lambda *s: torch.randn(*s, dtype=torch.bfloat16) * 0.1)(D, N)
        C_re = (lambda *s: torch.randn(*s, dtype=torch.bfloat16) * 0.1)(D, N)
        C_im = (lambda *s: torch.randn(*s, dtype=torch.bfloat16) * 0.1)(D, N)
        log_dt = (lambda *s: torch.randn(*s, dtype=torch.bfloat16) * 0.05)(D) * 0.5 - 4.0
        Dskip = (lambda *s: torch.randn(*s, dtype=torch.bfloat16) * 0.05)(D)
        return {
            "u": _w((lambda *s: torch.randn(*s, dtype=torch.bfloat16) * 0.05)(B, L, D)),
            "A_re": _w(A_re),
            "A_im": _w(A_im),
            "B_re": _w(B_re),
            "B_im": _w(B_im),
            "C_re": _w(C_re),
            "C_im": _w(C_im),
            "log_dt": _w(log_dt),
            "Dskip": _w(Dskip),
        }
    _A_in = _A_setup()

    def _B_setup():
        B, S, D, F = 1, 2048, 448, 1792
        return {
            "x": _w((lambda *s: torch.randn(*s, dtype=torch.bfloat16) * 0.05)(B, S, D)),
            "w1": _w((lambda *s: torch.randn(*s, dtype=torch.bfloat16) * 3.2)(D, F) * (D ** -0.5)),
            "b1": _w((lambda *s: torch.randn(*s, dtype=torch.bfloat16) * 0.8)(F)),
            "w2": _w((lambda *s: torch.randn(*s, dtype=torch.bfloat16) * 0.05)(F, D) * (F ** -0.5)),
            "b2": _w((lambda *s: torch.randn(*s, dtype=torch.bfloat16) * 0.05)(D)),
        }
    _B_in = _B_setup()

    return {
        "A_u": _A_in["u"],
        "A_A_re": _A_in["A_re"],
        "A_A_im": _A_in["A_im"],
        "A_B_re": _A_in["B_re"],
        "A_B_im": _A_in["B_im"],
        "A_C_re": _A_in["C_re"],
        "A_C_im": _A_in["C_im"],
        "A_log_dt": _A_in["log_dt"],
        "A_Dskip": _A_in["Dskip"],
        "B_x": _B_in["x"],
        "B_w1": _B_in["w1"],
        "B_b1": _B_in["b1"],
        "B_w2": _B_in["w2"],
        "B_b2": _B_in["b2"],
    }

def reference(A_u, A_A_re, A_A_im, A_B_re, A_B_im, A_C_re, A_C_im, A_log_dt, A_Dskip, B_x, B_w1, B_b1, B_w2, B_b2):
    def _A_ref(u, A_re, A_im, B_re, B_im, C_re, C_im, log_dt, Dskip):
        Bsz, L, D = u.shape
        dt = torch.exp(log_dt)[:, None]
        A = A_re + 1j * A_im
        Bc = B_re + 1j * B_im
        Cc = C_re + 1j * C_im
        logdA = dt * A
        dB = dt * Bc
        l = (lambda x, dt: x.to(dt))(torch.arange(L), A_re.dtype)
        P = torch.exp(logdA[:, :, None] * l[None, None, :])
        K = torch.einsum("dn,dnl,dn->dl", Cc, P, dB).real
        L2 = 2 * L
        Kp = _pad(K, ((0, 0), (0, L)))
        up = (lambda x, *d: x.permute(*d))(u, 0, 2, 1)
        up = _pad(up, ((0, 0), (0, 0), (0, L)))
        Kf = (lambda x, axes=(-2,-1): torch.fft.rfft2(x.float(), dim=axes))(Kp[:, None, :], axes=(-2, -1))
        Uf = (lambda x, axes=(-2,-1): torch.fft.rfft2(x.float(), dim=axes))(up[:, :, None, :], axes=(-2, -1))
        Yf = Uf * Kf[None, :, :, :]
        y = (lambda x, s, axes=(-2,-1): torch.fft.irfft2(x, s=s, dim=axes).to(torch.bfloat16))(Yf, (1, L2), axes=(-2, -1))[:, :, 0, :L]
        y = (lambda x, *d: x.permute(*d))(y, 0, 2, 1) + u * Dskip[None, None, :]
        return y

    def _B_ref(x, w1, b1, w2, b2):
        y = _layernorm(x, axis=-1)
        h = _gelu(torch.einsum("bsd,df->bsf", y, w1) + b1)
        return torch.einsum("bsf,fd->bsd", h, w2) + b2

    x = A_u
    xn = _layernorm(x, axis=-1)
    return x + _A_ref(xn, A_A_re, A_A_im, A_B_re, A_B_im, A_C_re, A_C_im, A_log_dt, A_Dskip) + _B_ref(xn, B_w1, B_b1, B_w2, B_b2)
```

```asm
; @launch kernel=main_kernel grid=(448,1,1) block=(512,1,1) lds=81920
.amdgcn_target "amdgcn-amd-amdhsa--gfx950"
.text
.globl main_kernel
.p2align 8
.type main_kernel,@function
main_kernel:
    s_cmp_ge_u32 s2, 448
    s_cbranch_scc1 L_done
    s_cmp_ge_u32 s2, 224
    s_cbranch_scc1 L_ssm
    s_load_dwordx2 s[4:5], s[0:1], 0
    s_load_dwordx8 s[8:15], s[0:1], 80
    s_load_dwordx4 s[16:19], s[0:1], 112
    s_load_dwordx2 s[6:7], s[0:1], 128
    s_and_b32 s20, s2, 7
    s_lshr_b32 s21, s2, 3
    s_cmp_ge_u32 s21, 14
    s_cselect_b32 s22, 1, 0
    s_cselect_b32 s23, 14, 0
    s_sub_u32 s23, s21, s23
    s_lshl_b32 s27, s20, 1
    s_add_u32 s27, s27, s22
    s_lshl_b32 s24, s23, 8
    s_mul_i32 s25, s27, 114688
    s_mov_b32 s96, s23
    s_mov_b32 s98, 0
    v_lshrrev_b32 v1, 6, v0
    s_nop 0
    v_readfirstlane_b32 s26, v1
    s_lshl_b32 s26, s26, 11
    v_bfe_u32 v10, v0, 3, 3
    v_and_b32 v11, 7, v0
    v_bfe_u32 v12, v0, 6, 2
    v_lshl_add_u32 v12, v12, 4, v10
    v_bfe_u32 v13, v10, 1, 1
    v_lshlrev_b32 v13, 2, v13
    v_xor_b32 v13, v13, v11
    v_mul_u32_u24 v14, 3584, v12
    v_lshl_add_u32 v2, v13, 4, v14
    v_lshrrev_b32 v13, 1, v10
    v_xor_b32 v13, v13, v11
    v_mul_u32_u24 v14, 896, v12
    v_lshl_add_u32 v4, v13, 4, v14
    v_xor_b32 v13, 4, v13
    v_lshl_add_u32 v5, v13, 4, v14
    v_add_u32 v5, 6144, v5
    v_lshrrev_b32 v13, 8, v0
    v_mul_u32_u24 v14, 128, v13
    v_add_u32 v2, v2, v14
    v_add_u32 v3, 27648, v2
    v_mul_u32_u24 v14, 57344, v13
    v_add_u32 v4, v4, v14
    v_add_u32 v5, v5, v14
    s_waitcnt lgkmcnt(0)
    s_mov_b32 s28, s8
    s_mov_b32 s29, s9
    s_mov_b32 s30, 0x188000
    s_mov_b32 s31, 0x00020000
    s_mov_b32 s32, s6
    s_mov_b32 s33, s7
    s_mov_b32 s34, 0x1c0000
    s_mov_b32 s35, 0x00020000
    s_mov_b32 s52, s18
    s_mov_b32 s53, s19
    s_mov_b32 s54, 0x100
    s_mov_b32 s55, 0x00020000
    s_mov_b32 s36, s4
    s_mov_b32 s37, s5
    s_mov_b32 s38, 0x1c0000
    s_mov_b32 s39, 0x00020000
    s_add_u32 s84, s6, 0x1800000
    s_addc_u32 s85, s7, 0
    s_mov_b32 s86, 0x4000
    s_mov_b32 s87, 0x00020000
    s_setprio 2
    s_cmp_ge_u32 s2, 128
    s_cbranch_scc1 L_noln
    s_lshl_b32 s3, s20, 8
    s_lshl_b32 s42, s21, 4
    s_add_u32 s3, s3, s42
    v_lshrrev_b32 v20, 5, v0
    v_and_b32 v21, 31, v0
    v_add_u32 v23, s3, v20
    v_mul_u32_u24 v22, 896, v23
    v_lshl_add_u32 v22, v21, 4, v22
    v_lshlrev_b32 v23, 2, v23
    v_cmp_gt_u32 s[40:41], 28, v21
    s_mov_b64 exec, s[40:41]
    buffer_load_dwordx4 v[32:35], v22, s[36:39], 0 offen
    buffer_load_dwordx4 v[36:39], v22, s[36:39], 0 offen offset:448
    s_mov_b64 exec, -1
    s_add_u32 m0, s26, 0
    s_add_u32 s48, s24, 0
    buffer_load_dwordx4 v2, s[28:31], s48 offen lds
    buffer_load_dwordx4 v3, s[28:31], s48 offen offset:1024 lds
    s_add_u32 m0, s26, 32768
    s_add_u32 s48, s24, 229376
    buffer_load_dwordx4 v2, s[28:31], s48 offen lds
    buffer_load_dwordx4 v3, s[28:31], s48 offen offset:1024 lds
    s_add_u32 m0, s26, 65536
    s_add_u32 s48, s24, 458752
    buffer_load_dwordx4 v2, s[28:31], s48 offen lds
    buffer_load_dwordx4 v3, s[28:31], s48 offen offset:1024 lds
    s_add_u32 s44, s6, 0x200000
    s_addc_u32 s45, s7, 0
    s_mov_b32 s46, 0x1c0000
    s_mov_b32 s47, 0x00020000
    v_sub_u32 v23, 15, v20
    v_mul_u32_u24 v23, 960, v23
    v_lshl_add_u32 v23, v21, 4, v23
    v_add_u32 v23, 16384, v23
    v_bfe_u32 v24, v0, 2, 2
    v_mul_u32_u24 v24, 960, v24
    v_and_b32 v25, 3, v0
    v_lshl_add_u32 v24, v25, 3, v24
    v_lshrrev_b32 v25, 4, v0
    v_lshl_add_u32 v24, v25, 5, v24
    v_add_u32 v24, 16384, v24
    s_lshr_b32 s43, s3, 4
    s_sub_u32 s43, 127, s43
    s_mul_i32 s43, s43, 14336
    v_lshlrev_b32 v25, 5, v0
    v_add_u32 v25, 49152, v25
    v_and_b32 v27, 63, v0
    v_lshl_add_u32 v27, v27, 4, s26
    v_add_u32 v26, 49152, v27
    s_waitcnt vmcnt(6)
    v_lshlrev_b32 v48, 16, v32
    v_and_b32 v49, 0xffff0000, v32
    v_lshlrev_b32 v50, 16, v33
    v_and_b32 v51, 0xffff0000, v33
    v_lshlrev_b32 v52, 16, v34
    v_and_b32 v53, 0xffff0000, v34
    v_lshlrev_b32 v54, 16, v35
    v_and_b32 v55, 0xffff0000, v35
    v_lshlrev_b32 v56, 16, v36
    v_and_b32 v57, 0xffff0000, v36
    v_lshlrev_b32 v58, 16, v37
    v_and_b32 v59, 0xffff0000, v37
    v_lshlrev_b32 v60, 16, v38
    v_and_b32 v61, 0xffff0000, v38
    v_lshlrev_b32 v62, 16, v39
    v_and_b32 v63, 0xffff0000, v39
    v_mov_b32 v64, 0
    s_mov_b64 exec, s[40:41]
    v_add_f32 v64, v48, v52
    v_add_f32 v65, v49, v53
    v_add_f32 v66, v50, v54
    v_add_f32 v67, v51, v55
    v_add_f32 v64, v64, v56
    v_add_f32 v65, v65, v57
    v_add_f32 v66, v66, v58
    v_add_f32 v67, v67, v59
    v_add_f32 v64, v64, v60
    v_add_f32 v65, v65, v61
    v_add_f32 v66, v66, v62
    v_add_f32 v67, v67, v63
    v_add_f32 v64, v64, v65
    v_add_f32 v66, v66, v67
    v_add_f32 v64, v64, v66
    s_mov_b64 exec, -1
    s_nop 1
    v_add_f32_dpp v64, v64, v64 row_ror:8 row_mask:0xf bank_mask:0xf
    s_nop 1
    v_add_f32_dpp v64, v64, v64 row_ror:4 row_mask:0xf bank_mask:0xf
    s_nop 1
    v_add_f32_dpp v64, v64, v64 row_ror:2 row_mask:0xf bank_mask:0xf
    s_nop 1
    v_add_f32_dpp v64, v64, v64 row_ror:1 row_mask:0xf bank_mask:0xf
    v_mov_b32 v70, v64
    s_nop 1
    v_permlane16_swap_b32 v64, v70
    v_add_f32 v64, v64, v70
    v_mul_f32 v68, 0x3b124925, v64
    v_mov_b32 v64, 0
    s_mov_b64 exec, s[40:41]
    v_sub_f32 v70, v48, v68
    v_mul_f32 v64, v70, v70
    v_sub_f32 v71, v49, v68
    v_mul_f32 v65, v71, v71
    v_sub_f32 v70, v50, v68
    v_mul_f32 v66, v70, v70
    v_sub_f32 v71, v51, v68
    v_mul_f32 v67, v71, v71
    v_sub_f32 v70, v52, v68
    v_fmac_f32 v64, v70, v70
    v_sub_f32 v71, v53, v68
    v_fmac_f32 v65, v71, v71
    v_sub_f32 v70, v54, v68
    v_fmac_f32 v66, v70, v70
    v_sub_f32 v71, v55, v68
    v_fmac_f32 v67, v71, v71
    v_sub_f32 v70, v56, v68
    v_fmac_f32 v64, v70, v70
    v_sub_f32 v71, v57, v68
    v_fmac_f32 v65, v71, v71
    v_sub_f32 v70, v58, v68
    v_fmac_f32 v66, v70, v70
    v_sub_f32 v71, v59, v68
    v_fmac_f32 v67, v71, v71
    v_sub_f32 v70, v60, v68
    v_fmac_f32 v64, v70, v70
    v_sub_f32 v71, v61, v68
    v_fmac_f32 v65, v71, v71
    v_sub_f32 v70, v62, v68
    v_fmac_f32 v66, v70, v70
    v_sub_f32 v71, v63, v68
    v_fmac_f32 v67, v71, v71
    v_add_f32 v64, v64, v65
    v_add_f32 v66, v66, v67
    v_add_f32 v64, v64, v66
    s_mov_b64 exec, -1
    s_nop 1
    v_add_f32_dpp v64, v64, v64 row_ror:8 row_mask:0xf bank_mask:0xf
    s_nop 1
    v_add_f32_dpp v64, v64, v64 row_ror:4 row_mask:0xf bank_mask:0xf
    s_nop 1
    v_add_f32_dpp v64, v64, v64 row_ror:2 row_mask:0xf bank_mask:0xf
    s_nop 1
    v_add_f32_dpp v64, v64, v64 row_ror:1 row_mask:0xf bank_mask:0xf
    v_mov_b32 v70, v64
    s_nop 1
    v_permlane16_swap_b32 v64, v70
    v_add_f32 v64, v64, v70
    v_mul_f32 v64, 0x3b124925, v64
    v_cvt_pk_bf16_f32 v65, v68, v64
    v_lshlrev_b32 v68, 16, v65
    v_and_b32 v64, 0xffff0000, v65
    v_add_f32 v64, 0x3727c5ac, v64
    v_cvt_pk_bf16_f32 v65, v64, v64
    v_lshlrev_b32 v64, 16, v65
    v_sqrt_f32 v64, v64
    s_nop 0
    v_cvt_pk_bf16_f32 v65, v64, v64
    v_lshlrev_b32 v64, 16, v65
    v_rcp_f32 v69, v64
    s_nop 0
    v_sub_f32 v48, v48, v68
    v_sub_f32 v49, v49, v68
    v_cvt_pk_bf16_f32 v32, v48, v49
    v_lshlrev_b32 v48, 16, v32
    v_and_b32 v49, 0xffff0000, v32
    v_mul_f32 v48, v48, v69
    v_mul_f32 v49, v49, v69
    v_cvt_pk_bf16_f32 v32, v48, v49
    v_lshlrev_b32 v48, 16, v32
    v_and_b32 v49, 0xffff0000, v32
    v_sub_f32 v50, v50, v68
    v_sub_f32 v51, v51, v68
    v_cvt_pk_bf16_f32 v33, v50, v51
    v_lshlrev_b32 v50, 16, v33
    v_and_b32 v51, 0xffff0000, v33
    v_mul_f32 v50, v50, v69
    v_mul_f32 v51, v51, v69
    v_cvt_pk_bf16_f32 v33, v50, v51
    v_lshlrev_b32 v50, 16, v33
    v_and_b32 v51, 0xffff0000, v33
    v_sub_f32 v52, v52, v68
    v_sub_f32 v53, v53, v68
    v_cvt_pk_bf16_f32 v34, v52, v53
    v_lshlrev_b32 v52, 16, v34
    v_and_b32 v53, 0xffff0000, v34
    v_mul_f32 v52, v52, v69
    v_mul_f32 v53, v53, v69
    v_cvt_pk_bf16_f32 v34, v52, v53
    v_lshlrev_b32 v52, 16, v34
    v_and_b32 v53, 0xffff0000, v34
    v_sub_f32 v54, v54, v68
    v_sub_f32 v55, v55, v68
    v_cvt_pk_bf16_f32 v35, v54, v55
    v_lshlrev_b32 v54, 16, v35
    v_and_b32 v55, 0xffff0000, v35
    v_mul_f32 v54, v54, v69
    v_mul_f32 v55, v55, v69
    v_cvt_pk_bf16_f32 v35, v54, v55
    v_lshlrev_b32 v54, 16, v35
    v_and_b32 v55, 0xffff0000, v35
    v_sub_f32 v56, v56, v68
    v_sub_f32 v57, v57, v68
    v_cvt_pk_bf16_f32 v36, v56, v57
    v_lshlrev_b32 v56, 16, v36
    v_and_b32 v57, 0xffff0000, v36
    v_mul_f32 v56, v56, v69
    v_mul_f32 v57, v57, v69
    v_cvt_pk_bf16_f32 v36, v56, v57
    v_lshlrev_b32 v56, 16, v36
    v_and_b32 v57, 0xffff0000, v36
    v_sub_f32 v58, v58, v68
    v_sub_f32 v59, v59, v68
    v_cvt_pk_bf16_f32 v37, v58, v59
    v_lshlrev_b32 v58, 16, v37
    v_and_b32 v59, 0xffff0000, v37
    v_mul_f32 v58, v58, v69
    v_mul_f32 v59, v59, v69
    v_cvt_pk_bf16_f32 v37, v58, v59
    v_lshlrev_b32 v58, 16, v37
    v_and_b32 v59, 0xffff0000, v37
    v_sub_f32 v60, v60, v68
    v_sub_f32 v61, v61, v68
    v_cvt_pk_bf16_f32 v38, v60, v61
    v_lshlrev_b32 v60, 16, v38
    v_and_b32 v61, 0xffff0000, v38
    v_mul_f32 v60, v60, v69
    v_mul_f32 v61, v61, v69
    v_cvt_pk_bf16_f32 v38, v60, v61
    v_lshlrev_b32 v60, 16, v38
    v_and_b32 v61, 0xffff0000, v38
    v_sub_f32 v62, v62, v68
    v_sub_f32 v63, v63, v68
    v_cvt_pk_bf16_f32 v39, v62, v63
    v_lshlrev_b32 v62, 16, v39
    v_and_b32 v63, 0xffff0000, v39
    v_mul_f32 v62, v62, v69
    v_mul_f32 v63, v63, v69
    v_cvt_pk_bf16_f32 v39, v62, v63
    v_lshlrev_b32 v62, 16, v39
    v_and_b32 v63, 0xffff0000, v39
    s_mov_b64 exec, s[40:41]
    ds_write_b128 v23, v[32:35]
    ds_write_b128 v23, v[36:39] offset:448
    s_mov_b64 exec, -1
    s_waitcnt lgkmcnt(0)
    s_barrier
    s_cmp_ge_u32 s26, 14336
    s_cbranch_scc1 L_ln_notr
    ds_read_b64_tr_b16 v[72:73], v24 offset:0
    ds_read_b64_tr_b16 v[74:75], v24 offset:3840
    ds_read_b64_tr_b16 v[76:77], v24 offset:7680
    ds_read_b64_tr_b16 v[78:79], v24 offset:11520
    s_waitcnt lgkmcnt(0)
    ds_write_b128 v25, v[72:75]
    ds_write_b128 v25, v[76:79] offset:16
    s_waitcnt lgkmcnt(0)
    ds_read_b128 v[80:83], v26
    ds_read_b128 v[84:87], v26 offset:1024
    s_waitcnt lgkmcnt(0)
    buffer_store_dwordx4 v[80:83], v27, s[44:47], s43 offen sc1
    buffer_store_dwordx4 v[84:87], v27, s[44:47], s43 offen offset:1024 sc1
L_ln_notr:
    s_cmp_lg_u32 s26, 0
    s_cbranch_scc1 L_ln_i
    v_mov_b32 v126, 0
    buffer_load_dword v125, v126, s[52:55], 0 offen offset:128 sc1
L_ln_i:
    v_mov_b32 v64, 0
    s_mov_b64 exec, s[40:41]
    v_add_f32 v64, v48, v52
    v_add_f32 v65, v49, v53
    v_add_f32 v66, v50, v54
    v_add_f32 v67, v51, v55
    v_add_f32 v64, v64, v56
    v_add_f32 v65, v65, v57
    v_add_f32 v66, v66, v58
    v_add_f32 v67, v67, v59
    v_add_f32 v64, v64, v60
    v_add_f32 v65, v65, v61
    v_add_f32 v66, v66, v62
    v_add_f32 v67, v67, v63
    v_add_f32 v64, v64, v65
    v_add_f32 v66, v66, v67
    v_add_f32 v64, v64, v66
    s_mov_b64 exec, -1
    s_nop 1
    v_add_f32_dpp v64, v64, v64 row_ror:8 row_mask:0xf bank_mask:0xf
    s_nop 1
    v_add_f32_dpp v64, v64, v64 row_ror:4 row_mask:0xf bank_mask:0xf
    s_nop 1
    v_add_f32_dpp v64, v64, v64 row_ror:2 row_mask:0xf bank_mask:0xf
    s_nop 1
    v_add_f32_dpp v64, v64, v64 row_ror:1 row_mask:0xf bank_mask:0xf
    v_mov_b32 v70, v64
    s_nop 1
    v_permlane16_swap_b32 v64, v70
    v_add_f32 v64, v64, v70
    v_mul_f32 v68, 0x3b124925, v64
    v_mov_b32 v64, 0
    s_mov_b64 exec, s[40:41]
    v_sub_f32 v70, v48, v68
    v_mul_f32 v64, v70, v70
    v_sub_f32 v71, v49, v68
    v_mul_f32 v65, v71, v71
    v_sub_f32 v70, v50, v68
    v_mul_f32 v66, v70, v70
    v_sub_f32 v71, v51, v68
    v_mul_f32 v67, v71, v71
    v_sub_f32 v70, v52, v68
    v_fmac_f32 v64, v70, v70
    v_sub_f32 v71, v53, v68
    v_fmac_f32 v65, v71, v71
    v_sub_f32 v70, v54, v68
    v_fmac_f32 v66, v70, v70
    v_sub_f32 v71, v55, v68
    v_fmac_f32 v67, v71, v71
    v_sub_f32 v70, v56, v68
    v_fmac_f32 v64, v70, v70
    v_sub_f32 v71, v57, v68
    v_fmac_f32 v65, v71, v71
    v_sub_f32 v70, v58, v68
    v_fmac_f32 v66, v70, v70
    v_sub_f32 v71, v59, v68
    v_fmac_f32 v67, v71, v71
    v_sub_f32 v70, v60, v68
    v_fmac_f32 v64, v70, v70
    v_sub_f32 v71, v61, v68
    v_fmac_f32 v65, v71, v71
    v_sub_f32 v70, v62, v68
    v_fmac_f32 v66, v70, v70
    v_sub_f32 v71, v63, v68
    v_fmac_f32 v67, v71, v71
    v_add_f32 v64, v64, v65
    v_add_f32 v66, v66, v67
    v_add_f32 v64, v64, v66
    s_mov_b64 exec, -1
    s_nop 1
    v_add_f32_dpp v64, v64, v64 row_ror:8 row_mask:0xf bank_mask:0xf
    s_nop 1
    v_add_f32_dpp v64, v64, v64 row_ror:4 row_mask:0xf bank_mask:0xf
    s_nop 1
    v_add_f32_dpp v64, v64, v64 row_ror:2 row_mask:0xf bank_mask:0xf
    s_nop 1
    v_add_f32_dpp v64, v64, v64 row_ror:1 row_mask:0xf bank_mask:0xf
    v_mov_b32 v70, v64
    s_nop 1
    v_permlane16_swap_b32 v64, v70
    v_add_f32 v64, v64, v70
    v_mul_f32 v64, 0x3b124925, v64
    v_cvt_pk_bf16_f32 v65, v68, v64
    v_lshlrev_b32 v68, 16, v65
    v_and_b32 v64, 0xffff0000, v65
    v_add_f32 v64, 0x3727c5ac, v64
    v_cvt_pk_bf16_f32 v65, v64, v64
    v_lshlrev_b32 v64, 16, v65
    v_sqrt_f32 v64, v64
    s_nop 0
    v_cvt_pk_bf16_f32 v65, v64, v64
    v_lshlrev_b32 v64, 16, v65
    v_rcp_f32 v69, v64
    s_nop 0
    v_sub_f32 v48, v48, v68
    v_sub_f32 v49, v49, v68
    v_cvt_pk_bf16_f32 v40, v48, v49
    v_lshlrev_b32 v48, 16, v40
    v_and_b32 v49, 0xffff0000, v40
    v_mul_f32 v48, v48, v69
    v_mul_f32 v49, v49, v69
    v_cvt_pk_bf16_f32 v40, v48, v49
    v_lshlrev_b32 v48, 16, v40
    v_and_b32 v49, 0xffff0000, v40
    v_sub_f32 v50, v50, v68
    v_sub_f32 v51, v51, v68
    v_cvt_pk_bf16_f32 v41, v50, v51
    v_lshlrev_b32 v50, 16, v41
    v_and_b32 v51, 0xffff0000, v41
    v_mul_f32 v50, v50, v69
    v_mul_f32 v51, v51, v69
    v_cvt_pk_bf16_f32 v41, v50, v51
    v_lshlrev_b32 v50, 16, v41
    v_and_b32 v51, 0xffff0000, v41
    v_sub_f32 v52, v52, v68
    v_sub_f32 v53, v53, v68
    v_cvt_pk_bf16_f32 v42, v52, v53
    v_lshlrev_b32 v52, 16, v42
    v_and_b32 v53, 0xffff0000, v42
    v_mul_f32 v52, v52, v69
    v_mul_f32 v53, v53, v69
    v_cvt_pk_bf16_f32 v42, v52, v53
    v_lshlrev_b32 v52, 16, v42
    v_and_b32 v53, 0xffff0000, v42
    v_sub_f32 v54, v54, v68
    v_sub_f32 v55, v55, v68
    v_cvt_pk_bf16_f32 v43, v54, v55
    v_lshlrev_b32 v54, 16, v43
    v_and_b32 v55, 0xffff0000, v43
    v_mul_f32 v54, v54, v69
    v_mul_f32 v55, v55, v69
    v_cvt_pk_bf16_f32 v43, v54, v55
    v_lshlrev_b32 v54, 16, v43
    v_and_b32 v55, 0xffff0000, v43
    v_sub_f32 v56, v56, v68
    v_sub_f32 v57, v57, v68
    v_cvt_pk_bf16_f32 v44, v56, v57
    v_lshlrev_b32 v56, 16, v44
    v_and_b32 v57, 0xffff0000, v44
    v_mul_f32 v56, v56, v69
    v_mul_f32 v57, v57, v69
    v_cvt_pk_bf16_f32 v44, v56, v57
    v_lshlrev_b32 v56, 16, v44
    v_and_b32 v57, 0xffff0000, v44
    v_sub_f32 v58, v58, v68
    v_sub_f32 v59, v59, v68
    v_cvt_pk_bf16_f32 v45, v58, v59
    v_lshlrev_b32 v58, 16, v45
    v_and_b32 v59, 0xffff0000, v45
    v_mul_f32 v58, v58, v69
    v_mul_f32 v59, v59, v69
    v_cvt_pk_bf16_f32 v45, v58, v59
    v_lshlrev_b32 v58, 16, v45
    v_and_b32 v59, 0xffff0000, v45
    v_sub_f32 v60, v60, v68
    v_sub_f32 v61, v61, v68
    v_cvt_pk_bf16_f32 v46, v60, v61
    v_lshlrev_b32 v60, 16, v46
    v_and_b32 v61, 0xffff0000, v46
    v_mul_f32 v60, v60, v69
    v_mul_f32 v61, v61, v69
    v_cvt_pk_bf16_f32 v46, v60, v61
    v_lshlrev_b32 v60, 16, v46
    v_and_b32 v61, 0xffff0000, v46
    v_sub_f32 v62, v62, v68
    v_sub_f32 v63, v63, v68
    v_cvt_pk_bf16_f32 v47, v62, v63
    v_lshlrev_b32 v62, 16, v47
    v_and_b32 v63, 0xffff0000, v47
    v_mul_f32 v62, v62, v69
    v_mul_f32 v63, v63, v69
    v_cvt_pk_bf16_f32 v47, v62, v63
    v_lshlrev_b32 v62, 16, v47
    v_and_b32 v63, 0xffff0000, v47
    s_mov_b64 exec, s[40:41]
    buffer_store_dwordx4 v[40:43], v22, s[32:35], 0 offen sc1
    buffer_store_dwordx4 v[44:47], v22, s[32:35], 0 offen offset:448 sc1
    s_mov_b64 exec, -1
    s_lshr_b32 s42, s3, 7
    s_lshl_b32 s42, s42, 8
    s_waitcnt vmcnt(0)
    s_barrier
    s_cmp_lg_u32 s26, 0
    s_cbranch_scc1 L_sig1
    s_mov_b64 exec, 1
    v_mov_b32 v126, 0
    v_mov_b32 v127, 1
    s_mov_b32 s49, 0
L_sig1_i:
    v_readfirstlane_b32 s92, v125
    s_cmp_eq_u32 s92, 1
    s_cbranch_scc1 L_sig1_k
    s_add_u32 s49, s49, 1
    s_cmp_gt_u32 s49, 262144
    s_cbranch_scc1 L_sig1_k
    buffer_load_dword v125, v126, s[52:55], 0 offen offset:128 sc1
    s_waitcnt vmcnt(0)
    s_branch L_sig1_i
L_sig1_k:
    s_mov_b32 s98, s92
    buffer_atomic_add v127, v126, s[84:87], s42 offen offset:0 sc1
    s_mov_b64 exec, -1
L_sig1:
    s_branch L_ln_done
L_noln:
    s_cmp_lg_u32 s2, 128
    s_cbranch_scc1 L_noinit
    s_cmp_lg_u32 s26, 0
    s_cbranch_scc1 L_noinit
    v_lshlrev_b32 v126, 8, v0
    v_mov_b32 v127, 0
    v_mov_b32 v125, 1
    v_mov_b32 v116, 0
    v_mov_b32 v117, 0
    v_mov_b32 v118, 0
    v_mov_b32 v119, 0
    buffer_store_dwordx4 v[116:119], v126, s[84:87], 0 offen offset:0 sc1
    buffer_store_dwordx4 v[116:119], v126, s[84:87], 0 offen offset:16 sc1
    buffer_store_dwordx4 v[116:119], v126, s[84:87], 0 offen offset:32 sc1
    buffer_store_dwordx4 v[116:119], v126, s[84:87], 0 offen offset:48 sc1
    s_waitcnt vmcnt(0)
    s_mov_b64 exec, 1
    buffer_store_dword v125, v127, s[52:55], 0 offen offset:128 sc1
    s_mov_b64 exec, -1
L_noinit:
    s_sleep 20
    s_add_u32 m0, s26, 0
    s_add_u32 s48, s24, 0
    buffer_load_dwordx4 v2, s[28:31], s48 offen lds
    buffer_load_dwordx4 v3, s[28:31], s48 offen offset:1024 lds
    s_add_u32 m0, s26, 32768
    s_add_u32 s48, s24, 229376
    buffer_load_dwordx4 v2, s[28:31], s48 offen lds
    buffer_load_dwordx4 v3, s[28:31], s48 offen offset:1024 lds
    s_add_u32 m0, s26, 65536
    s_add_u32 s48, s24, 458752
    buffer_load_dwordx4 v2, s[28:31], s48 offen lds
    buffer_load_dwordx4 v3, s[28:31], s48 offen offset:1024 lds
    s_sleep 20
L_ln_done:
    s_setprio 0
    v_lshrrev_b32 v20, 8, v0
    v_bfe_u32 v21, v0, 6, 2
    v_lshlrev_b32 v21, 5, v21
    v_bfe_u32 v10, v0, 2, 2
    v_and_b32 v11, 3, v0
    v_bfe_u32 v12, v0, 4, 1
    v_lshrrev_b32 v13, 1, v11
    v_lshl_add_u32 v13, v12, 1, v13
    v_bfe_u32 v12, v10, 1, 1
    v_lshl_or_b32 v13, v12, 2, v13
    v_bfe_u32 v12, v0, 5, 1
    v_lshl_add_u32 v14, v12, 3, v10
    v_lshlrev_b32 v14, 7, v14
    v_and_b32 v11, 1, v11
    v_lshl_add_u32 v14, v11, 3, v14
    v_lshl_add_u32 v6, v13, 4, v14
    v_xor_b32 v7, 64, v6
    v_and_b32 v10, 31, v0
    v_bfe_u32 v13, v10, 1, 3
    v_xor_b32 v13, v13, v12
    v_add_u32 v10, v10, v21
    v_lshlrev_b32 v10, 7, v10
    v_xor_b32 v11, 0, v13
    v_lshl_add_u32 v16, v11, 4, v10
    v_xor_b32 v11, 2, v13
    v_lshl_add_u32 v17, v11, 4, v10
    v_xor_b32 v11, 4, v13
    v_lshl_add_u32 v18, v11, 4, v10
    v_xor_b32 v11, 6, v13
    v_lshl_add_u32 v19, v11, 4, v10
    v_lshlrev_b32 v10, 13, v20
    v_add_u32 v6, v6, v10
    v_add_u32 v7, v7, v10
    v_add_u32 v8, 0xc000, v6
    v_add_u32 v9, 0xc000, v7
    v_bfe_u32 v10, v0, 5, 1
    v_lshlrev_b32 v11, 7, v20
    v_lshl_add_u32 v26, v10, 3, v11
    v_add_u32 v26, s24, v26
    v_and_b32 v12, 15, v0
    v_add_u32 v12, v21, v12
    s_lshl_b32 s42, s27, 7
    v_add_u32 v12, s42, v12
    v_mul_u32_u24 v12, 3712, v12
    v_lshl_add_u32 v27, v10, 4, v11
    v_add3_u32 v27, v27, v12, s24
    v_bfe_u32 v12, v0, 4, 1
    v_lshl_add_u32 v27, v12, 5, v27
    v_add_u32 v29, 59392, v27
    s_mov_b32 s40, s10
    s_mov_b32 s41, s11
    s_mov_b32 s42, 0xe00
    s_mov_b32 s43, 0x00020000
    s_add_u32 s44, s6, 0x800000
    s_addc_u32 s45, s7, 0
    s_mov_b32 s46, 0x740000
    s_mov_b32 s47, 0x00020000
    buffer_load_dwordx2 v[88:89], v26, s[40:43], 0 offen offset:0
    buffer_load_dwordx2 v[90:91], v26, s[40:43], 0 offen offset:16
    buffer_load_dwordx2 v[92:93], v26, s[40:43], 0 offen offset:32
    buffer_load_dwordx2 v[94:95], v26, s[40:43], 0 offen offset:48
    buffer_load_dwordx2 v[96:97], v26, s[40:43], 0 offen offset:64
    buffer_load_dwordx2 v[98:99], v26, s[40:43], 0 offen offset:80
    buffer_load_dwordx2 v[100:101], v26, s[40:43], 0 offen offset:96
    buffer_load_dwordx2 v[102:103], v26, s[40:43], 0 offen offset:112
    s_lshl_b32 s42, s27, 8
    v_mov_b32 v121, 49152
    s_lshl_b32 s92, s20, 3
    s_cmp_lg_u32 s26, 0
    s_cbranch_scc1 L_w2_d
    s_mov_b64 exec, 0x1
    v_lshlrev_b32 v126, 8, v0
    v_mov_b32 v124, 0
    s_mov_b32 s49, 0
    s_cmp_eq_u32 s98, 1
    s_cbranch_scc1 L_w2
L_w2_i:
    buffer_load_dword v125, v124, s[52:55], 0 offen offset:128 sc1
    s_add_u32 s49, s49, 1
    s_waitcnt vmcnt(0)
    v_readfirstlane_b32 s98, v125
    s_cmp_eq_u32 s98, 1
    s_cbranch_scc1 L_w2
    s_cmp_gt_u32 s49, 262144
    s_cbranch_scc1 L_w2
    s_sleep 2
    s_branch L_w2_i
L_w2:
    buffer_load_dword v127, v126, s[84:87], s42 offen offset:0 sc1
    s_add_u32 s49, s49, 1
    s_waitcnt vmcnt(0)
    v_cmp_ne_u32 vcc, 8, v127
    s_cmp_gt_u32 s49, 262144
    s_cbranch_scc1 L_w2_x
    s_cbranch_vccz L_w2_x
    s_sleep 2
    s_branch L_w2
L_w2_x:
    s_mov_b64 exec, -1
L_w2_d:
    s_barrier
    s_add_u32 m0, s26, 16384
    s_add_u32 s48, s25, 0
    buffer_load_dwordx4 v4, s[32:35], s48 offen lds
    buffer_load_dwordx4 v5, s[32:35], s48 offen offset:1024 lds
    s_add_u32 m0, s26, 49152
    s_add_u32 s48, s25, 128
    buffer_load_dwordx4 v4, s[32:35], s48 offen lds
    buffer_load_dwordx4 v5, s[32:35], s48 offen offset:1024 lds
    s_mul_i32 s22, s21, 37
    s_lshr_b32 s22, s22, 8
    s_mul_i32 s23, s22, 7
    s_sub_u32 s21, s21, s23
    s_lshl_b32 s20, s20, 2
    s_add_u32 s20, s20, s22
    s_lshl_b32 s22, s21, 7
    s_mul_i32 s23, s20, 237568
    v_bfe_u32 v10, v0, 3, 3
    v_and_b32 v11, 7, v0
    v_bfe_u32 v12, v0, 6, 2
    v_lshl_add_u32 v12, v12, 4, v10
    v_bfe_u32 v13, v10, 1, 1
    v_lshlrev_b32 v13, 2, v13
    v_xor_b32 v13, v13, v11
    v_mul_u32_u24 v14, 896, v12
    v_lshl_add_u32 v104, v13, 4, v14
    v_lshrrev_b32 v13, 1, v10
    v_xor_b32 v13, v13, v11
    v_mul_u32_u24 v14, 3712, v12
    v_lshl_add_u32 v106, v13, 4, v14
    v_xor_b32 v13, 4, v13
    v_lshl_add_u32 v107, v13, 4, v14
    v_add_u32 v107, 28672, v107
    v_lshrrev_b32 v13, 8, v0
    v_mul_u32_u24 v14, 57344, v13
    v_add_u32 v104, v104, v14
    v_add_u32 v105, 6144, v104
    v_mul_u32_u24 v14, 128, v13
    v_add_u32 v106, v106, v14
    v_add_u32 v107, v107, v14
    s_mov_b32 s56, s12
    s_mov_b32 s57, s13
    s_mov_b32 s58, 0x188000
    s_mov_b32 s59, 0x00020000
    s_waitcnt vmcnt(2)
    s_barrier
    v_add_u32 v22, 16384, v16
    v_add_u32 v23, 16384, v17
    v_add_u32 v24, 16384, v18
    v_add_u32 v25, 16384, v19
    ds_read_b128 v[40:43], v22
    ds_read_b64_tr_b16 v[32:33], v6 offset:0
    ds_read_b64_tr_b16 v[34:35], v6 offset:512
    ds_read_b64_tr_b16 v[36:37], v7 offset:0
    ds_read_b64_tr_b16 v[38:39], v7 offset:512
    ds_read_b128 v[52:55], v23
    ds_read_b64_tr_b16 v[44:45], v6 offset:2048
    ds_read_b64_tr_b16 v[46:47], v6 offset:2560
    ds_read_b64_tr_b16 v[48:49], v7 offset:2048
    ds_read_b64_tr_b16 v[50:51], v7 offset:2560
    s_waitcnt lgkmcnt(5)
    v_mfma_f32_32x32x16_bf16 v[56:71], v[32:35], v[40:43], 0
    v_mfma_f32_32x32x16_bf16 v[72:87], v[36:39], v[40:43], 0
    ds_read_b128 v[40:43], v24
    ds_read_b64_tr_b16 v[32:33], v6 offset:4096
    ds_read_b64_tr_b16 v[34:35], v6 offset:4608
    ds_read_b64_tr_b16 v[36:37], v7 offset:4096
    ds_read_b64_tr_b16 v[38:39], v7 offset:4608
    s_waitcnt lgkmcnt(5)
    v_mfma_f32_32x32x16_bf16 v[56:71], v[44:47], v[52:55], v[56:71]
    v_mfma_f32_32x32x16_bf16 v[72:87], v[48:51], v[52:55], v[72:87]
    ds_read_b128 v[52:55], v25
    ds_read_b64_tr_b16 v[44:45], v6 offset:6144
    ds_read_b64_tr_b16 v[46:47], v6 offset:6656
    ds_read_b64_tr_b16 v[48:49], v7 offset:6144
    ds_read_b64_tr_b16 v[50:51], v7 offset:6656
    s_waitcnt lgkmcnt(5)
    v_mfma_f32_32x32x16_bf16 v[56:71], v[32:35], v[40:43], v[56:71]
    v_mfma_f32_32x32x16_bf16 v[72:87], v[36:39], v[40:43], v[72:87]
    s_waitcnt lgkmcnt(0)
    v_mfma_f32_32x32x16_bf16 v[56:71], v[44:47], v[52:55], v[56:71]
    v_mfma_f32_32x32x16_bf16 v[72:87], v[48:51], v[52:55], v[72:87]
    s_waitcnt vmcnt(0)
    s_barrier
    v_add_u32 v22, 49152, v16
    v_add_u32 v23, 49152, v17
    v_add_u32 v24, 49152, v18
    v_add_u32 v25, 49152, v19
    ds_read_b128 v[40:43], v22
    ds_read_b64_tr_b16 v[32:33], v6 offset:32768
    ds_read_b64_tr_b16 v[34:35], v6 offset:33280
    ds_read_b64_tr_b16 v[36:37], v7 offset:32768
    ds_read_b64_tr_b16 v[38:39], v7 offset:33280
    ds_read_b128 v[52:55], v23
    ds_read_b64_tr_b16 v[44:45], v6 offset:34816
    ds_read_b64_tr_b16 v[46:47], v6 offset:35328
    ds_read_b64_tr_b16 v[48:49], v7 offset:34816
    ds_read_b64_tr_b16 v[50:51], v7 offset:35328
    s_waitcnt lgkmcnt(5)
    v_mfma_f32_32x32x16_bf16 v[56:71], v[32:35], v[40:43], v[56:71]
    v_mfma_f32_32x32x16_bf16 v[72:87], v[36:39], v[40:43], v[72:87]
    s_add_u32 m0, s26, 0
    s_add_u32 s48, s25, 256
    buffer_load_dwordx4 v4, s[32:35], s48 offen lds
    buffer_load_dwordx4 v5, s[32:35], s48 offen offset:1024 lds
    ds_read_b128 v[40:43], v24
    ds_read_b64_tr_b16 v[32:33], v6 offset:36864
    ds_read_b64_tr_b16 v[34:35], v6 offset:37376
    ds_read_b64_tr_b16 v[36:37], v7 offset:36864
    ds_read_b64_tr_b16 v[38:39], v7 offset:37376
    s_waitcnt lgkmcnt(5)
    v_mfma_f32_32x32x16_bf16 v[56:71], v[44:47], v[52:55], v[56:71]
    v_mfma_f32_32x32x16_bf16 v[72:87], v[48:51], v[52:55], v[72:87]
    s_add_u32 m0, s26, 16384
    s_add_u32 s48, s24, 688128
    buffer_load_dwordx4 v2, s[28:31], s48 offen lds
    buffer_load_dwordx4 v3, s[28:31], s48 offen offset:1024 lds
    ds_read_b128 v[52:55], v25
    ds_read_b64_tr_b16 v[44:45], v6 offset:38912
    ds_read_b64_tr_b16 v[46:47], v6 offset:39424
    ds_read_b64_tr_b16 v[48:49], v7 offset:38912
    ds_read_b64_tr_b16 v[50:51], v7 offset:39424
    s_waitcnt lgkmcnt(5)
    v_mfma_f32_32x32x16_bf16 v[56:71], v[32:35], v[40:43], v[56:71]
    v_mfma_f32_32x32x16_bf16 v[72:87], v[36:39], v[40:43], v[72:87]
    s_waitcnt lgkmcnt(0)
    v_mfma_f32_32x32x16_bf16 v[56:71], v[44:47], v[52:55], v[56:71]
    v_mfma_f32_32x32x16_bf16 v[72:87], v[48:51], v[52:55], v[72:87]
    s_waitcnt vmcnt(2)
    s_barrier
    v_add_u32 v22, 0, v16
    v_add_u32 v23, 0, v17
    v_add_u32 v24, 0, v18
    v_add_u32 v25, 0, v19
    ds_read_b128 v[40:43], v22
    ds_read_b64_tr_b16 v[32:33], v8 offset:16384
    ds_read_b64_tr_b16 v[34:35], v8 offset:16896
    ds_read_b64_tr_b16 v[36:37], v9 offset:16384
    ds_read_b64_tr_b16 v[38:39], v9 offset:16896
    ds_read_b128 v[52:55], v23
    ds_read_b64_tr_b16 v[44:45], v8 offset:18432
    ds_read_b64_tr_b16 v[46:47], v8 offset:18944
    ds_read_b64_tr_b16 v[48:49], v9 offset:18432
    ds_read_b64_tr_b16 v[50:51], v9 offset:18944
    s_waitcnt lgkmcnt(5)
    v_mfma_f32_32x32x16_bf16 v[56:71], v[32:35], v[40:43], v[56:71]
    v_mfma_f32_32x32x16_bf16 v[72:87], v[36:39], v[40:43], v[72:87]
    s_add_u32 m0, s26, 32768
    s_add_u32 s48, s25, 384
    buffer_load_dwordx4 v4, s[32:35], s48 offen lds
    buffer_load_dwordx4 v5, s[32:35], s48 offen offset:1024 lds
    ds_read_b128 v[40:43], v24
    ds_read_b64_tr_b16 v[32:33], v8 offset:20480
    ds_read_b64_tr_b16 v[34:35], v8 offset:20992
    ds_read_b64_tr_b16 v[36:37], v9 offset:20480
    ds_read_b64_tr_b16 v[38:39], v9 offset:20992
    s_waitcnt lgkmcnt(5)
    v_mfma_f32_32x32x16_bf16 v[56:71], v[44:47], v[52:55], v[56:71]
    v_mfma_f32_32x32x16_bf16 v[72:87], v[48:51], v[52:55], v[72:87]
    s_add_u32 m0, s26, 49152
    s_add_u32 s48, s24, 917504
    buffer_load_dwordx4 v2, s[28:31], s48 offen lds
    buffer_load_dwordx4 v3, s[28:31], s48 offen offset:1024 lds
    ds_read_b128 v[52:55], v25
    ds_read_b64_tr_b16 v[44:45], v8 offset:22528
    ds_read_b64_tr_b16 v[46:47], v8 offset:23040
    ds_read_b64_tr_b16 v[48:49], v9 offset:22528
    ds_read_b64_tr_b16 v[50:51], v9 offset:23040
    s_waitcnt lgkmcnt(5)
    v_mfma_f32_32x32x16_bf16 v[56:71], v[32:35], v[40:43], v[56:71]
    v_mfma_f32_32x32x16_bf16 v[72:87], v[36:39], v[40:43], v[72:87]
    s_waitcnt lgkmcnt(0)
    v_mfma_f32_32x32x16_bf16 v[56:71], v[44:47], v[52:55], v[56:71]
    v_mfma_f32_32x32x16_bf16 v[72:87], v[48:51], v[52:55], v[72:87]
    s_waitcnt vmcnt(2)
    s_barrier
    v_add_u32 v22, 32768, v16
    v_add_u32 v23, 32768, v17
    v_add_u32 v24, 32768, v18
    v_add_u32 v25, 32768, v19
    ds_read_b128 v[40:43], v22
    ds_read_b64_tr_b16 v[32:33], v6 offset:16384
    ds_read_b64_tr_b16 v[34:35], v6 offset:16896
    ds_read_b64_tr_b16 v[36:37], v7 offset:16384
    ds_read_b64_tr_b16 v[38:39], v7 offset:16896
    ds_read_b128 v[52:55], v23
    ds_read_b64_tr_b16 v[44:45], v6 offset:18432
    ds_read_b64_tr_b16 v[46:47], v6 offset:18944
    ds_read_b64_tr_b16 v[48:49], v7 offset:18432
    ds_read_b64_tr_b16 v[50:51], v7 offset:18944
    s_waitcnt lgkmcnt(5)
    v_mfma_f32_32x32x16_bf16 v[56:71], v[32:35], v[40:43], v[56:71]
    v_mfma_f32_32x32x16_bf16 v[72:87], v[36:39], v[40:43], v[72:87]
    s_add_u32 m0, s26, 65536
    s_add_u32 s48, s25, 512
    buffer_load_dwordx4 v4, s[32:35], s48 offen lds
    buffer_load_dwordx4 v5, s[32:35], s48 offen offset:1024 lds
    ds_read_b128 v[40:43], v24
    ds_read_b64_tr_b16 v[32:33], v6 offset:20480
    ds_read_b64_tr_b16 v[34:35], v6 offset:20992
    ds_read_b64_tr_b16 v[36:37], v7 offset:20480
    ds_read_b64_tr_b16 v[38:39], v7 offset:20992
    s_waitcnt lgkmcnt(5)
    v_mfma_f32_32x32x16_bf16 v[56:71], v[44:47], v[52:55], v[56:71]
    v_mfma_f32_32x32x16_bf16 v[72:87], v[48:51], v[52:55], v[72:87]
    s_add_u32 m0, s26, 0
    s_add_u32 s48, s24, 1146880
    buffer_load_dwordx4 v2, s[28:31], s48 offen lds
    buffer_load_dwordx4 v3, s[28:31], s48 offen offset:1024 lds
    ds_read_b128 v[52:55], v25
    ds_read_b64_tr_b16 v[44:45], v6 offset:22528
    ds_read_b64_tr_b16 v[46:47], v6 offset:23040
    ds_read_b64_tr_b16 v[48:49], v7 offset:22528
    ds_read_b64_tr_b16 v[50:51], v7 offset:23040
    s_waitcnt lgkmcnt(5)
    v_mfma_f32_32x32x16_bf16 v[56:71], v[32:35], v[40:43], v[56:71]
    v_mfma_f32_32x32x16_bf16 v[72:87], v[36:39], v[40:43], v[72:87]
    s_waitcnt lgkmcnt(0)
    v_mfma_f32_32x32x16_bf16 v[56:71], v[44:47], v[52:55], v[56:71]
    v_mfma_f32_32x32x16_bf16 v[72:87], v[48:51], v[52:55], v[72:87]
    s_waitcnt vmcnt(2)
    s_barrier
    v_add_u32 v22, 65536, v16
    v_add_u32 v23, 65536, v17
    v_add_u32 v24, 65536, v18
    v_add_u32 v25, 65536, v19
    ds_read_b128 v[40:43], v22
    ds_read_b64_tr_b16 v[32:33], v8 offset:0
    ds_read_b64_tr_b16 v[34:35], v8 offset:512
    ds_read_b64_tr_b16 v[36:37], v9 offset:0
    ds_read_b64_tr_b16 v[38:39], v9 offset:512
    ds_read_b128 v[52:55], v23
    ds_read_b64_tr_b16 v[44:45], v8 offset:2048
    ds_read_b64_tr_b16 v[46:47], v8 offset:2560
    ds_read_b64_tr_b16 v[48:49], v9 offset:2048
    ds_read_b64_tr_b16 v[50:51], v9 offset:2560
    s_waitcnt lgkmcnt(5)
    v_mfma_f32_32x32x16_bf16 v[56:71], v[32:35], v[40:43], v[56:71]
    v_mfma_f32_32x32x16_bf16 v[72:87], v[36:39], v[40:43], v[72:87]
    s_add_u32 m0, s26, 16384
    s_add_u32 s48, s25, 640
    buffer_load_dwordx4 v4, s[32:35], s48 offen lds
    buffer_load_dwordx4 v5, s[32:35], s48 offen offset:1024 lds
    ds_read_b128 v[40:43], v24
    ds_read_b64_tr_b16 v[32:33], v8 offset:4096
    ds_read_b64_tr_b16 v[34:35], v8 offset:4608
    ds_read_b64_tr_b16 v[36:37], v9 offset:4096
    ds_read_b64_tr_b16 v[38:39], v9 offset:4608
    s_waitcnt lgkmcnt(5)
    v_mfma_f32_32x32x16_bf16 v[56:71], v[44:47], v[52:55], v[56:71]
    v_mfma_f32_32x32x16_bf16 v[72:87], v[48:51], v[52:55], v[72:87]
    s_add_u32 m0, s26, 32768
    s_add_u32 s48, s24, 1376256
    buffer_load_dwordx4 v2, s[28:31], s48 offen lds
    buffer_load_dwordx4 v3, s[28:31], s48 offen offset:1024 lds
    ds_read_b128 v[52:55], v25
    ds_read_b64_tr_b16 v[44:45], v8 offset:6144
    ds_read_b64_tr_b16 v[46:47], v8 offset:6656
    ds_read_b64_tr_b16 v[48:49], v9 offset:6144
    ds_read_b64_tr_b16 v[50:51], v9 offset:6656
    s_waitcnt lgkmcnt(5)
    v_mfma_f32_32x32x16_bf16 v[56:71], v[32:35], v[40:43], v[56:71]
    v_mfma_f32_32x32x16_bf16 v[72:87], v[36:39], v[40:43], v[72:87]
    s_waitcnt lgkmcnt(0)
    v_mfma_f32_32x32x16_bf16 v[56:71], v[44:47], v[52:55], v[56:71]
    v_mfma_f32_32x32x16_bf16 v[72:87], v[48:51], v[52:55], v[72:87]
    s_waitcnt vmcnt(2)
    s_barrier
    v_add_u32 v22, 16384, v16
    v_add_u32 v23, 16384, v17
    v_add_u32 v24, 16384, v18
    v_add_u32 v25, 16384, v19
    ds_read_b128 v[40:43], v22
    ds_read_b64_tr_b16 v[32:33], v6 offset:0
    ds_read_b64_tr_b16 v[34:35], v6 offset:512
    ds_read_b64_tr_b16 v[36:37], v7 offset:0
    ds_read_b64_tr_b16 v[38:39], v7 offset:512
    ds_read_b128 v[52:55], v23
    ds_read_b64_tr_b16 v[44:45], v6 offset:2048
    ds_read_b64_tr_b16 v[46:47], v6 offset:2560
    ds_read_b64_tr_b16 v[48:49], v7 offset:2048
    ds_read_b64_tr_b16 v[50:51], v7 offset:2560
    s_waitcnt lgkmcnt(5)
    v_mfma_f32_32x32x16_bf16 v[56:71], v[32:35], v[40:43], v[56:71]
    v_mfma_f32_32x32x16_bf16 v[72:87], v[36:39], v[40:43], v[72:87]
    s_add_u32 m0, s26, 49152
    s_add_u32 s48, s25, 768
    buffer_load_dwordx4 v4, s[32:35], s48 offen lds
    buffer_load_dwordx4 v5, s[32:35], s48 offen offset:1024 lds
    ds_read_b128 v[40:43], v24
    ds_read_b64_tr_b16 v[32:33], v6 offset:4096
    ds_read_b64_tr_b16 v[34:35], v6 offset:4608
    ds_read_b64_tr_b16 v[36:37], v7 offset:4096
    ds_read_b64_tr_b16 v[38:39], v7 offset:4608
    s_waitcnt lgkmcnt(5)
    v_mfma_f32_32x32x16_bf16 v[56:71], v[44:47], v[52:55], v[56:71]
    v_mfma_f32_32x32x16_bf16 v[72:87], v[48:51], v[52:55], v[72:87]
    s_add_u32 s97, s96, 0
    s_cmp_ge_u32 s97, 14
    s_cselect_b32 s98, 14, 0
    s_sub_u32 s97, s97, s98
    s_mul_i32 s97, s97, 114688
    s_add_u32 m0, s26, 65536
    s_add_u32 s48, s22, s97
    buffer_load_dwordx4 v104, s[56:59], s48 offen lds
    buffer_load_dwordx4 v105, s[56:59], s48 offen offset:1024 lds
    ds_read_b128 v[52:55], v25
    ds_read_b64_tr_b16 v[44:45], v6 offset:6144
    ds_read_b64_tr_b16 v[46:47], v6 offset:6656
    ds_read_b64_tr_b16 v[48:49], v7 offset:6144
    ds_read_b64_tr_b16 v[50:51], v7 offset:6656
    s_waitcnt lgkmcnt(5)
    v_mfma_f32_32x32x16_bf16 v[56:71], v[32:35], v[40:43], v[56:71]
    v_mfma_f32_32x32x16_bf16 v[72:87], v[36:39], v[40:43], v[72:87]
    s_waitcnt lgkmcnt(0)
    v_mfma_f32_32x32x16_bf16 v[56:71], v[44:47], v[52:55], v[56:71]
    v_mfma_f32_32x32x16_bf16 v[72:87], v[48:51], v[52:55], v[72:87]
    s_waitcnt vmcnt(2)
    s_barrier
    v_add_u32 v22, 49152, v16
    v_add_u32 v23, 49152, v17
    v_add_u32 v24, 49152, v18
    v_add_u32 v25, 49152, v19
    ds_read_b128 v[40:43], v22
    ds_read_b64_tr_b16 v[32:33], v6 offset:32768
    ds_read_b64_tr_b16 v[34:35], v6 offset:33280
    ds_read_b64_tr_b16 v[36:37], v7 offset:32768
    ds_read_b64_tr_b16 v[38:39], v7 offset:33280
    ds_read_b128 v[52:55], v23
    ds_read_b64_tr_b16 v[44:45], v6 offset:34816
    ds_read_b64_tr_b16 v[46:47], v6 offset:35328
    ds_read_b64_tr_b16 v[48:49], v7 offset:34816
    ds_read_b64_tr_b16 v[50:51], v7 offset:35328
    s_waitcnt lgkmcnt(5)
    v_mfma_f32_32x32x16_bf16 v[56:71], v[32:35], v[40:43], v[56:71]
    v_mfma_f32_32x32x16_bf16 v[72:87], v[36:39], v[40:43], v[72:87]
    ds_read_b128 v[40:43], v24
    ds_read_b64_tr_b16 v[32:33], v6 offset:36864
    ds_read_b64_tr_b16 v[34:35], v6 offset:37376
    ds_read_b64_tr_b16 v[36:37], v7 offset:36864
    ds_read_b64_tr_b16 v[38:39], v7 offset:37376
    s_waitcnt lgkmcnt(5)
    v_mfma_f32_32x32x16_bf16 v[56:71], v[44:47], v[52:55], v[56:71]
    v_mfma_f32_32x32x16_bf16 v[72:87], v[48:51], v[52:55], v[72:87]
    s_add_u32 s97, s96, 1
    s_cmp_ge_u32 s97, 14
    s_cselect_b32 s98, 14, 0
    s_sub_u32 s97, s97, s98
    s_mul_i32 s97, s97, 114688
    s_add_u32 m0, s26, 16384
    s_add_u32 s48, s22, s97
    buffer_load_dwordx4 v104, s[56:59], s48 offen lds
    buffer_load_dwordx4 v105, s[56:59], s48 offen offset:1024 lds
    ds_read_b128 v[52:55], v25
    ds_read_b64_tr_b16 v[44:45], v6 offset:38912
    ds_read_b64_tr_b16 v[46:47], v6 offset:39424
    ds_read_b64_tr_b16 v[48:49], v7 offset:38912
    ds_read_b64_tr_b16 v[50:51], v7 offset:39424
    s_waitcnt lgkmcnt(5)
    v_mfma_f32_32x32x16_bf16 v[56:71], v[32:35], v[40:43], v[56:71]
    v_mfma_f32_32x32x16_bf16 v[72:87], v[36:39], v[40:43], v[72:87]
    s_waitcnt lgkmcnt(0)
    v_mfma_f32_32x32x16_bf16 v[56:71], v[44:47], v[52:55], v[56:71]
    v_mfma_f32_32x32x16_bf16 v[72:87], v[48:51], v[52:55], v[72:87]
    s_mov_b32 s42, 0xbdd2d3e8
    v_mov_b32 v28, 0xc0135761
    s_nop 7
    v_cvt_pk_bf16_f32 v50, v56, v57
    v_lshlrev_b32 v48, 16, v88
    v_and_b32 v49, 0xffff0000, v88
    v_lshlrev_b32 v56, 16, v50
    v_and_b32 v57, 0xffff0000, v50
    v_add_f32 v56, v56, v48
    v_add_f32 v57, v57, v49
    v_cvt_pk_bf16_f32 v50, v56, v57
    v_lshlrev_b32 v56, 16, v50
    v_and_b32 v57, 0xffff0000, v50
    v_mul_f32 v48, v56, v56
    v_mul_f32 v49, v57, v57
    v_fma_f32 v48, v48, s42, v28
    v_fma_f32 v49, v49, s42, v28
    v_mul_f32 v48, v56, v48
    v_mul_f32 v49, v57, v49
    v_exp_f32 v48, v48
    v_exp_f32 v49, v49
    s_nop 0
    v_add_f32 v48, 1.0, v48
    v_add_f32 v49, 1.0, v49
    v_rcp_f32 v48, v48
    v_rcp_f32 v49, v49
    s_nop 0
    v_mul_f32 v56, v56, v48
    v_mul_f32 v57, v57, v49
    v_cvt_pk_bf16_f32 v32, v56, v57
    v_cvt_pk_bf16_f32 v54, v58, v59
    v_lshlrev_b32 v52, 16, v89
    v_and_b32 v53, 0xffff0000, v89
    v_lshlrev_b32 v58, 16, v54
    v_and_b32 v59, 0xffff0000, v54
    v_add_f32 v58, v58, v52
    v_add_f32 v59, v59, v53
    v_cvt_pk_bf16_f32 v54, v58, v59
    v_lshlrev_b32 v58, 16, v54
    v_and_b32 v59, 0xffff0000, v54
    v_mul_f32 v52, v58, v58
    v_mul_f32 v53, v59, v59
    v_fma_f32 v52, v52, s42, v28
    v_fma_f32 v53, v53, s42, v28
    v_mul_f32 v52, v58, v52
    v_mul_f32 v53, v59, v53
    v_exp_f32 v52, v52
    v_exp_f32 v53, v53
    s_nop 0
    v_add_f32 v52, 1.0, v52
    v_add_f32 v53, 1.0, v53
    v_rcp_f32 v52, v52
    v_rcp_f32 v53, v53
    s_nop 0
    v_mul_f32 v58, v58, v52
    v_mul_f32 v59, v59, v53
    v_cvt_pk_bf16_f32 v33, v58, v59
    v_cvt_pk_bf16_f32 v50, v60, v61
    v_lshlrev_b32 v48, 16, v90
    v_and_b32 v49, 0xffff0000, v90
    v_lshlrev_b32 v60, 16, v50
    v_and_b32 v61, 0xffff0000, v50
    v_add_f32 v60, v60, v48
    v_add_f32 v61, v61, v49
    v_cvt_pk_bf16_f32 v50, v60, v61
    v_lshlrev_b32 v60, 16, v50
    v_and_b32 v61, 0xffff0000, v50
    v_mul_f32 v48, v60, v60
    v_mul_f32 v49, v61, v61
    v_fma_f32 v48, v48, s42, v28
    v_fma_f32 v49, v49, s42, v28
    v_mul_f32 v48, v60, v48
    v_mul_f32 v49, v61, v49
    v_exp_f32 v48, v48
    v_exp_f32 v49, v49
    s_nop 0
    v_add_f32 v48, 1.0, v48
    v_add_f32 v49, 1.0, v49
    v_rcp_f32 v48, v48
    v_rcp_f32 v49, v49
    s_nop 0
    v_mul_f32 v60, v60, v48
    v_mul_f32 v61, v61, v49
    v_cvt_pk_bf16_f32 v34, v60, v61
    v_cvt_pk_bf16_f32 v54, v62, v63
    v_lshlrev_b32 v52, 16, v91
    v_and_b32 v53, 0xffff0000, v91
    v_lshlrev_b32 v62, 16, v54
    v_and_b32 v63, 0xffff0000, v54
    v_add_f32 v62, v62, v52
    v_add_f32 v63, v63, v53
    v_cvt_pk_bf16_f32 v54, v62, v63
    v_lshlrev_b32 v62, 16, v54
    v_and_b32 v63, 0xffff0000, v54
    v_mul_f32 v52, v62, v62
    v_mul_f32 v53, v63, v63
    v_fma_f32 v52, v52, s42, v28
    v_fma_f32 v53, v53, s42, v28
    v_mul_f32 v52, v62, v52
    v_mul_f32 v53, v63, v53
    v_exp_f32 v52, v52
    v_exp_f32 v53, v53
    s_nop 0
    v_add_f32 v52, 1.0, v52
    v_add_f32 v53, 1.0, v53
    v_rcp_f32 v52, v52
    v_rcp_f32 v53, v53
    s_nop 0
    v_mul_f32 v62, v62, v52
    v_mul_f32 v63, v63, v53
    v_cvt_pk_bf16_f32 v35, v62, v63
    s_nop 1
    v_permlane32_swap_b32 v32, v34
    v_permlane32_swap_b32 v33, v35
    v_cvt_pk_bf16_f32 v50, v64, v65
    v_lshlrev_b32 v48, 16, v92
    v_and_b32 v49, 0xffff0000, v92
    v_lshlrev_b32 v64, 16, v50
    v_and_b32 v65, 0xffff0000, v50
    v_add_f32 v64, v64, v48
    v_add_f32 v65, v65, v49
    v_cvt_pk_bf16_f32 v50, v64, v65
    v_lshlrev_b32 v64, 16, v50
    v_and_b32 v65, 0xffff0000, v50
    v_mul_f32 v48, v64, v64
    v_mul_f32 v49, v65, v65
    v_fma_f32 v48, v48, s42, v28
    v_fma_f32 v49, v49, s42, v28
    v_mul_f32 v48, v64, v48
    v_mul_f32 v49, v65, v49
    v_exp_f32 v48, v48
    v_exp_f32 v49, v49
    s_nop 0
    v_add_f32 v48, 1.0, v48
    v_add_f32 v49, 1.0, v49
    v_rcp_f32 v48, v48
    v_rcp_f32 v49, v49
    s_nop 0
    v_mul_f32 v64, v64, v48
    v_mul_f32 v65, v65, v49
    v_cvt_pk_bf16_f32 v36, v64, v65
    v_cvt_pk_bf16_f32 v54, v66, v67
    v_lshlrev_b32 v52, 16, v93
    v_and_b32 v53, 0xffff0000, v93
    v_lshlrev_b32 v66, 16, v54
    v_and_b32 v67, 0xffff0000, v54
    v_add_f32 v66, v66, v52
    v_add_f32 v67, v67, v53
    v_cvt_pk_bf16_f32 v54, v66, v67
    v_lshlrev_b32 v66, 16, v54
    v_and_b32 v67, 0xffff0000, v54
    v_mul_f32 v52, v66, v66
    v_mul_f32 v53, v67, v67
    v_fma_f32 v52, v52, s42, v28
    v_fma_f32 v53, v53, s42, v28
    v_mul_f32 v52, v66, v52
    v_mul_f32 v53, v67, v53
    v_exp_f32 v52, v52
    v_exp_f32 v53, v53
    s_nop 0
    v_add_f32 v52, 1.0, v52
    v_add_f32 v53, 1.0, v53
    v_rcp_f32 v52, v52
    v_rcp_f32 v53, v53
    s_nop 0
    v_mul_f32 v66, v66, v52
    v_mul_f32 v67, v67, v53
    v_cvt_pk_bf16_f32 v37, v66, v67
    v_cvt_pk_bf16_f32 v50, v68, v69
    v_lshlrev_b32 v48, 16, v94
    v_and_b32 v49, 0xffff0000, v94
    v_lshlrev_b32 v68, 16, v50
    v_and_b32 v69, 0xffff0000, v50
    v_add_f32 v68, v68, v48
    v_add_f32 v69, v69, v49
    v_cvt_pk_bf16_f32 v50, v68, v69
    v_lshlrev_b32 v68, 16, v50
    v_and_b32 v69, 0xffff0000, v50
    v_mul_f32 v48, v68, v68
    v_mul_f32 v49, v69, v69
    v_fma_f32 v48, v48, s42, v28
    v_fma_f32 v49, v49, s42, v28
    v_mul_f32 v48, v68, v48
    v_mul_f32 v49, v69, v49
    v_exp_f32 v48, v48
    v_exp_f32 v49, v49
    s_nop 0
    v_add_f32 v48, 1.0, v48
    v_add_f32 v49, 1.0, v49
    v_rcp_f32 v48, v48
    v_rcp_f32 v49, v49
    s_nop 0
    v_mul_f32 v68, v68, v48
    v_mul_f32 v69, v69, v49
    v_cvt_pk_bf16_f32 v38, v68, v69
    v_cvt_pk_bf16_f32 v54, v70, v71
    v_lshlrev_b32 v52, 16, v95
    v_and_b32 v53, 0xffff0000, v95
    v_lshlrev_b32 v70, 16, v54
    v_and_b32 v71, 0xffff0000, v54
    v_add_f32 v70, v70, v52
    v_add_f32 v71, v71, v53
    v_cvt_pk_bf16_f32 v54, v70, v71
    v_lshlrev_b32 v70, 16, v54
    v_and_b32 v71, 0xffff0000, v54
    v_mul_f32 v52, v70, v70
    v_mul_f32 v53, v71, v71
    v_fma_f32 v52, v52, s42, v28
    v_fma_f32 v53, v53, s42, v28
    v_mul_f32 v52, v70, v52
    v_mul_f32 v53, v71, v53
    v_exp_f32 v52, v52
    v_exp_f32 v53, v53
    s_nop 0
    v_add_f32 v52, 1.0, v52
    v_add_f32 v53, 1.0, v53
    v_rcp_f32 v52, v52
    v_rcp_f32 v53, v53
    s_nop 0
    v_mul_f32 v70, v70, v52
    v_mul_f32 v71, v71, v53
    v_cvt_pk_bf16_f32 v39, v70, v71
    s_nop 1
    v_permlane32_swap_b32 v36, v38
    v_permlane32_swap_b32 v37, v39
    s_nop 1
    v_permlane16_swap_b32 v32, v36
    v_permlane16_swap_b32 v33, v37
    v_permlane16_swap_b32 v34, v38
    v_permlane16_swap_b32 v35, v39
    buffer_store_dwordx4 v[32:35], v27, s[44:47], 0 offen offset:0 sc1
    buffer_store_dwordx4 v[36:39], v29, s[44:47], 0 offen offset:0 sc1
    v_cvt_pk_bf16_f32 v50, v72, v73
    v_lshlrev_b32 v48, 16, v96
    v_and_b32 v49, 0xffff0000, v96
    v_lshlrev_b32 v72, 16, v50
    v_and_b32 v73, 0xffff0000, v50
    v_add_f32 v72, v72, v48
    v_add_f32 v73, v73, v49
    v_cvt_pk_bf16_f32 v50, v72, v73
    v_lshlrev_b32 v72, 16, v50
    v_and_b32 v73, 0xffff0000, v50
    v_mul_f32 v48, v72, v72
    v_mul_f32 v49, v73, v73
    v_fma_f32 v48, v48, s42, v28
    v_fma_f32 v49, v49, s42, v28
    v_mul_f32 v48, v72, v48
    v_mul_f32 v49, v73, v49
    v_exp_f32 v48, v48
    v_exp_f32 v49, v49
    s_nop 0
    v_add_f32 v48, 1.0, v48
    v_add_f32 v49, 1.0, v49
    v_rcp_f32 v48, v48
    v_rcp_f32 v49, v49
    s_nop 0
    v_mul_f32 v72, v72, v48
    v_mul_f32 v73, v73, v49
    v_cvt_pk_bf16_f32 v40, v72, v73
    v_cvt_pk_bf16_f32 v54, v74, v75
    v_lshlrev_b32 v52, 16, v97
    v_and_b32 v53, 0xffff0000, v97
    v_lshlrev_b32 v74, 16, v54
    v_and_b32 v75, 0xffff0000, v54
    v_add_f32 v74, v74, v52
    v_add_f32 v75, v75, v53
    v_cvt_pk_bf16_f32 v54, v74, v75
    v_lshlrev_b32 v74, 16, v54
    v_and_b32 v75, 0xffff0000, v54
    v_mul_f32 v52, v74, v74
    v_mul_f32 v53, v75, v75
    v_fma_f32 v52, v52, s42, v28
    v_fma_f32 v53, v53, s42, v28
    v_mul_f32 v52, v74, v52
    v_mul_f32 v53, v75, v53
    v_exp_f32 v52, v52
    v_exp_f32 v53, v53
    s_nop 0
    v_add_f32 v52, 1.0, v52
    v_add_f32 v53, 1.0, v53
    v_rcp_f32 v52, v52
    v_rcp_f32 v53, v53
    s_nop 0
    v_mul_f32 v74, v74, v52
    v_mul_f32 v75, v75, v53
    v_cvt_pk_bf16_f32 v41, v74, v75
    v_cvt_pk_bf16_f32 v50, v76, v77
    v_lshlrev_b32 v48, 16, v98
    v_and_b32 v49, 0xffff0000, v98
    v_lshlrev_b32 v76, 16, v50
    v_and_b32 v77, 0xffff0000, v50
    v_add_f32 v76, v76, v48
    v_add_f32 v77, v77, v49
    v_cvt_pk_bf16_f32 v50, v76, v77
    v_lshlrev_b32 v76, 16, v50
    v_and_b32 v77, 0xffff0000, v50
    v_mul_f32 v48, v76, v76
    v_mul_f32 v49, v77, v77
    v_fma_f32 v48, v48, s42, v28
    v_fma_f32 v49, v49, s42, v28
    v_mul_f32 v48, v76, v48
    v_mul_f32 v49, v77, v49
    v_exp_f32 v48, v48
    v_exp_f32 v49, v49
    s_nop 0
    v_add_f32 v48, 1.0, v48
    v_add_f32 v49, 1.0, v49
    v_rcp_f32 v48, v48
    v_rcp_f32 v49, v49
    s_nop 0
    v_mul_f32 v76, v76, v48
    v_mul_f32 v77, v77, v49
    v_cvt_pk_bf16_f32 v42, v76, v77
    v_cvt_pk_bf16_f32 v54, v78, v79
    v_lshlrev_b32 v52, 16, v99
    v_and_b32 v53, 0xffff0000, v99
    v_lshlrev_b32 v78, 16, v54
    v_and_b32 v79, 0xffff0000, v54
    v_add_f32 v78, v78, v52
    v_add_f32 v79, v79, v53
    v_cvt_pk_bf16_f32 v54, v78, v79
    v_lshlrev_b32 v78, 16, v54
    v_and_b32 v79, 0xffff0000, v54
    v_mul_f32 v52, v78, v78
    v_mul_f32 v53, v79, v79
    v_fma_f32 v52, v52, s42, v28
    v_fma_f32 v53, v53, s42, v28
    v_mul_f32 v52, v78, v52
    v_mul_f32 v53, v79, v53
    v_exp_f32 v52, v52
    v_exp_f32 v53, v53
    s_nop 0
    v_add_f32 v52, 1.0, v52
    v_add_f32 v53, 1.0, v53
    v_rcp_f32 v52, v52
    v_rcp_f32 v53, v53
    s_nop 0
    v_mul_f32 v78, v78, v52
    v_mul_f32 v79, v79, v53
    v_cvt_pk_bf16_f32 v43, v78, v79
    s_nop 1
    v_permlane32_swap_b32 v40, v42
    v_permlane32_swap_b32 v41, v43
    v_cvt_pk_bf16_f32 v50, v80, v81
    v_lshlrev_b32 v48, 16, v100
    v_and_b32 v49, 0xffff0000, v100
    v_lshlrev_b32 v80, 16, v50
    v_and_b32 v81, 0xffff0000, v50
    v_add_f32 v80, v80, v48
    v_add_f32 v81, v81, v49
    v_cvt_pk_bf16_f32 v50, v80, v81
    v_lshlrev_b32 v80, 16, v50
    v_and_b32 v81, 0xffff0000, v50
    v_mul_f32 v48, v80, v80
    v_mul_f32 v49, v81, v81
    v_fma_f32 v48, v48, s42, v28
    v_fma_f32 v49, v49, s42, v28
    v_mul_f32 v48, v80, v48
    v_mul_f32 v49, v81, v49
    v_exp_f32 v48, v48
    v_exp_f32 v49, v49
    s_nop 0
    v_add_f32 v48, 1.0, v48
    v_add_f32 v49, 1.0, v49
    v_rcp_f32 v48, v48
    v_rcp_f32 v49, v49
    s_nop 0
    v_mul_f32 v80, v80, v48
    v_mul_f32 v81, v81, v49
    v_cvt_pk_bf16_f32 v44, v80, v81
    v_cvt_pk_bf16_f32 v54, v82, v83
    v_lshlrev_b32 v52, 16, v101
    v_and_b32 v53, 0xffff0000, v101
    v_lshlrev_b32 v82, 16, v54
    v_and_b32 v83, 0xffff0000, v54
    v_add_f32 v82, v82, v52
    v_add_f32 v83, v83, v53
    v_cvt_pk_bf16_f32 v54, v82, v83
    v_lshlrev_b32 v82, 16, v54
    v_and_b32 v83, 0xffff0000, v54
    v_mul_f32 v52, v82, v82
    v_mul_f32 v53, v83, v83
    v_fma_f32 v52, v52, s42, v28
    v_fma_f32 v53, v53, s42, v28
    v_mul_f32 v52, v82, v52
    v_mul_f32 v53, v83, v53
    v_exp_f32 v52, v52
    v_exp_f32 v53, v53
    s_nop 0
    v_add_f32 v52, 1.0, v52
    v_add_f32 v53, 1.0, v53
    v_rcp_f32 v52, v52
    v_rcp_f32 v53, v53
    s_nop 0
    v_mul_f32 v82, v82, v52
    v_mul_f32 v83, v83, v53
    v_cvt_pk_bf16_f32 v45, v82, v83
    v_cvt_pk_bf16_f32 v50, v84, v85
    v_lshlrev_b32 v48, 16, v102
    v_and_b32 v49, 0xffff0000, v102
    v_lshlrev_b32 v84, 16, v50
    v_and_b32 v85, 0xffff0000, v50
    v_add_f32 v84, v84, v48
    v_add_f32 v85, v85, v49
    v_cvt_pk_bf16_f32 v50, v84, v85
    v_lshlrev_b32 v84, 16, v50
    v_and_b32 v85, 0xffff0000, v50
    v_mul_f32 v48, v84, v84
    v_mul_f32 v49, v85, v85
    v_fma_f32 v48, v48, s42, v28
    v_fma_f32 v49, v49, s42, v28
    v_mul_f32 v48, v84, v48
    v_mul_f32 v49, v85, v49
    v_exp_f32 v48, v48
    v_exp_f32 v49, v49
    s_nop 0
    v_add_f32 v48, 1.0, v48
    v_add_f32 v49, 1.0, v49
    v_rcp_f32 v48, v48
    v_rcp_f32 v49, v49
    s_nop 0
    v_mul_f32 v84, v84, v48
    v_mul_f32 v85, v85, v49
    v_cvt_pk_bf16_f32 v46, v84, v85
    v_cvt_pk_bf16_f32 v54, v86, v87
    v_lshlrev_b32 v52, 16, v103
    v_and_b32 v53, 0xffff0000, v103
    v_lshlrev_b32 v86, 16, v54
    v_and_b32 v87, 0xffff0000, v54
    v_add_f32 v86, v86, v52
    v_add_f32 v87, v87, v53
    v_cvt_pk_bf16_f32 v54, v86, v87
    v_lshlrev_b32 v86, 16, v54
    v_and_b32 v87, 0xffff0000, v54
    v_mul_f32 v52, v86, v86
    v_mul_f32 v53, v87, v87
    v_fma_f32 v52, v52, s42, v28
    v_fma_f32 v53, v53, s42, v28
    v_mul_f32 v52, v86, v52
    v_mul_f32 v53, v87, v53
    v_exp_f32 v52, v52
    v_exp_f32 v53, v53
    s_nop 0
    v_add_f32 v52, 1.0, v52
    v_add_f32 v53, 1.0, v53
    v_rcp_f32 v52, v52
    v_rcp_f32 v53, v53
    s_nop 0
    v_mul_f32 v86, v86, v52
    v_mul_f32 v87, v87, v53
    v_cvt_pk_bf16_f32 v47, v86, v87
    s_nop 1
    v_permlane32_swap_b32 v44, v46
    v_permlane32_swap_b32 v45, v47
    s_nop 1
    v_permlane16_swap_b32 v40, v44
    v_permlane16_swap_b32 v41, v45
    v_permlane16_swap_b32 v42, v46
    v_permlane16_swap_b32 v43, v47
    buffer_store_dwordx4 v[40:43], v27, s[44:47], 0 offen offset:64 sc1
    buffer_store_dwordx4 v[44:47], v29, s[44:47], 0 offen offset:64 sc1
    s_lshl_b32 s42, s27, 8
    s_add_u32 s42, s42, 4096
    s_lshl_b32 s92, s96, 2
    s_add_u32 s92, s92, s42
    s_waitcnt vmcnt(0)
    s_barrier
    s_cmp_lg_u32 s26, 0
    s_cbranch_scc1 L_hs
    s_mov_b64 exec, 1
    v_mov_b32 v126, 0
    v_mov_b32 v127, 1
    buffer_store_dword v127, v126, s[84:87], s92 offen sc1
    s_mov_b64 exec, -1
L_hs:
    s_add_u32 s97, s96, 0
    s_cmp_ge_u32 s97, 14
    s_cselect_b32 s98, 14, 0
    s_sub_u32 s97, s97, s98
    s_mul_i32 s97, s97, 256
    s_add_u32 m0, s26, 0
    s_add_u32 s48, s23, s97
    buffer_load_dwordx4 v106, s[44:47], s48 offen lds
    buffer_load_dwordx4 v107, s[44:47], s48 offen offset:1024 lds
    s_add_u32 s97, s96, 2
    s_cmp_ge_u32 s97, 14
    s_cselect_b32 s98, 14, 0
    s_sub_u32 s97, s97, s98
    s_mul_i32 s97, s97, 114688
    s_add_u32 m0, s26, 49152
    s_add_u32 s48, s22, s97
    buffer_load_dwordx4 v104, s[56:59], s48 offen lds
    buffer_load_dwordx4 v105, s[56:59], s48 offen offset:1024 lds
    v_bfe_u32 v20, v0, 7, 1
    v_bfe_u32 v21, v0, 6, 1
    v_lshlrev_b32 v22, 5, v21
    v_lshrrev_b32 v23, 8, v0
    v_bfe_u32 v10, v0, 2, 2
    v_and_b32 v11, 3, v0
    v_bfe_u32 v12, v0, 4, 1
    v_lshrrev_b32 v13, 1, v11
    v_lshl_add_u32 v13, v12, 1, v13
    v_bfe_u32 v12, v10, 1, 1
    v_lshl_or_b32 v13, v12, 2, v13
    v_bfe_u32 v12, v0, 5, 1
    v_lshl_add_u32 v14, v12, 3, v10
    v_lshlrev_b32 v14, 7, v14
    v_and_b32 v11, 1, v11
    v_lshl_add_u32 v14, v11, 3, v14
    v_lshlrev_b32 v11, 2, v20
    v_xor_b32 v13, v13, v11
    v_lshl_add_u32 v6, v13, 4, v14
    v_and_b32 v10, 31, v0
    v_bfe_u32 v13, v10, 1, 3
    v_xor_b32 v13, v13, v12
    v_add_u32 v10, v10, v22
    v_lshlrev_b32 v10, 7, v10
    v_xor_b32 v11, 0, v13
    v_lshl_add_u32 v16, v11, 4, v10
    v_xor_b32 v11, 2, v13
    v_lshl_add_u32 v17, v11, 4, v10
    v_xor_b32 v11, 4, v13
    v_lshl_add_u32 v18, v11, 4, v10
    v_xor_b32 v11, 6, v13
    v_lshl_add_u32 v19, v11, 4, v10
    v_lshlrev_b32 v10, 13, v23
    v_add_u32 v6, v6, v10
    v_add_u32 v16, v16, v10
    v_add_u32 v17, v17, v10
    v_add_u32 v18, v18, v10
    v_add_u32 v19, v19, v10
    v_bfe_u32 v10, v0, 5, 1
    v_and_b32 v12, 31, v0
    v_add_u32 v12, v12, v22
    v_lshlrev_b32 v11, 5, v20
    v_lshl_add_u32 v11, v23, 4, v11
    v_lshl_add_u32 v11, v10, 2, v11
    v_lshlrev_b32 v29, 7, v11
    v_lshl_add_u32 v29, v12, 1, v29
    v_add_u32 v29, 32768, v29
    v_lshl_add_u32 v28, v11, 1, s22
    s_lshl_b32 s42, s20, 6
    v_add_u32 v12, s42, v12
    v_mul_u32_u24 v13, 896, v12
    v_add_u32 v30, v13, v28
    v_lshl_add_u32 v31, v10, 3, v30
    v_lshrrev_b32 v13, 3, v0
    v_mul_u32_u24 v13, 4224, v13
    v_and_b32 v14, 7, v0
    v_lshl_add_u32 v8, v14, 4, v13
    s_mul_i32 s24, s21, 270336
    s_lshl_b32 s25, s20, 7
    s_add_u32 s24, s24, s25
    v_and_b32 v13, 255, v0
    v_lshlrev_b32 v13, 4, v13
    v_lshl_add_u32 v9, v23, 13, v13
    v_xor_b32 v15, 0x2000, v9
    v_add_u32 v9, 49152, v9
    v_add_u32 v15, 49152, v15
    s_mov_b32 s28, s14
    s_mov_b32 s29, s15
    s_mov_b32 s30, 0x380
    s_mov_b32 s31, 0x00020000
    s_add_u32 s32, s6, 0x1000000
    s_addc_u32 s33, s7, 0
    s_mov_b32 s34, 0x1ce000
    s_mov_b32 s35, 0x00020000
    s_mov_b32 s80, s16
    s_mov_b32 s81, s17
    s_mov_b32 s82, 0x1c0000
    s_mov_b32 s83, 0x00020000
    buffer_load_dwordx2 v[80:81], v30, s[36:39], 0 offen offset:0
    buffer_load_dwordx2 v[82:83], v30, s[36:39], 0 offen offset:16
    buffer_load_dwordx2 v[84:85], v28, s[28:31], 0 offen offset:0
    buffer_load_dwordx2 v[86:87], v28, s[28:31], 0 offen offset:16
    s_lshr_b32 s99, s20, 1
    s_lshl_b32 s99, s99, 8
    s_add_u32 s99, s99, 4096
    s_mov_b32 s94, 0
    s_lshl_b32 s92, s21, 8
    s_add_u32 s92, s92, 8192
    v_add_u32 v3, s96, v0
    v_subrev_u32 v2, 14, v3
    v_cmp_lt_u32 vcc, 13, v3
    s_nop 1
    v_cndmask_b32 v3, v3, v2, vcc
    v_lshlrev_b32 v3, 2, v3
    s_mov_b32 s93, 0
    s_cmp_lg_u32 s26, 0
    s_cbranch_scc1 L_hw1
    s_and_b32 s95, s93, 2
    s_cmp_eq_u32 s95, 2
    s_cbranch_scc1 L_hp3_y
    s_mov_b64 exec, 0x3fff
    s_mov_b32 s49, 0
L_hp3:
    buffer_load_dword v127, v3, s[84:87], s99 offen sc1
    s_waitcnt vmcnt(0)
L_hp3_c:
    v_cmp_eq_u32 vcc, 1, v127
    s_add_u32 s49, s49, 1
    s_mov_b32 s93, vcc_lo
    s_and_b32 s95, vcc_lo, 2
    s_cmp_eq_u32 s95, 2
    s_cbranch_scc1 L_hp3_x
    s_cmp_gt_u32 s49, 262144
    s_cbranch_scc1 L_hp3_x
    s_sleep 2
    s_branch L_hp3
L_hp3_x:
    s_mov_b64 exec, -1
L_hp3_y:
L_hw1:
    s_barrier
    s_add_u32 s97, s96, 1
    s_cmp_ge_u32 s97, 14
    s_cselect_b32 s98, 14, 0
    s_sub_u32 s97, s97, s98
    s_mul_i32 s97, s97, 256
    s_add_u32 m0, s26, 32768
    s_add_u32 s48, s23, s97
    buffer_load_dwordx4 v106, s[44:47], s48 offen lds
    buffer_load_dwordx4 v107, s[44:47], s48 offen offset:1024 lds
    s_waitcnt vmcnt(8)
    s_barrier
    v_add_u32 v7, 65536, v6
    v_add_u32 v24, 0, v16
    v_add_u32 v25, 0, v17
    v_add_u32 v26, 0, v18
    v_add_u32 v27, 0, v19
    ds_read_b64_tr_b16 v[48:49], v7 offset:0
    ds_read_b64_tr_b16 v[50:51], v7 offset:512
    ds_read_b128 v[52:55], v24
    ds_read_b64_tr_b16 v[56:57], v7 offset:2048
    ds_read_b64_tr_b16 v[58:59], v7 offset:2560
    ds_read_b128 v[60:63], v25
    ds_read_b64_tr_b16 v[64:65], v7 offset:4096
    ds_read_b64_tr_b16 v[66:67], v7 offset:4608
    ds_read_b128 v[68:71], v26
    ds_read_b64_tr_b16 v[72:73], v7 offset:6144
    ds_read_b64_tr_b16 v[74:75], v7 offset:6656
    ds_read_b128 v[76:79], v27
    s_cmp_lg_u32 s26, 0
    s_cbranch_scc1 L_hw20
    s_and_b32 s95, s93, 6
    s_cmp_eq_u32 s95, 6
    s_cbranch_scc1 L_hp4_y
    s_mov_b64 exec, 0x3fff
    s_mov_b32 s49, 0
L_hp4:
    buffer_load_dword v127, v3, s[84:87], s99 offen sc1
    s_waitcnt vmcnt(0)
L_hp4_c:
    v_cmp_eq_u32 vcc, 1, v127
    s_add_u32 s49, s49, 1
    s_mov_b32 s93, vcc_lo
    s_and_b32 s95, vcc_lo, 6
    s_cmp_eq_u32 s95, 6
    s_cbranch_scc1 L_hp4_x
    s_cmp_gt_u32 s49, 262144
    s_cbranch_scc1 L_hp4_x
    s_sleep 2
    s_branch L_hp4
L_hp4_x:
    s_mov_b64 exec, -1
L_hp4_y:
L_hw20:
    s_waitcnt lgkmcnt(0)
    s_barrier
    s_add_u32 s97, s96, 2
    s_cmp_ge_u32 s97, 14
    s_cselect_b32 s98, 14, 0
    s_sub_u32 s97, s97, s98
    s_mul_i32 s97, s97, 256
    s_add_u32 m0, s26, 65536
    s_add_u32 s48, s23, s97
    buffer_load_dwordx4 v106, s[44:47], s48 offen lds
    buffer_load_dwordx4 v107, s[44:47], s48 offen offset:1024 lds
    s_add_u32 s97, s96, 3
    s_cmp_ge_u32 s97, 14
    s_cselect_b32 s98, 14, 0
    s_sub_u32 s97, s97, s98
    s_mul_i32 s97, s97, 114688
    s_add_u32 m0, s26, 0
    s_add_u32 s48, s22, s97
    buffer_load_dwordx4 v104, s[56:59], s48 offen lds
    buffer_load_dwordx4 v105, s[56:59], s48 offen offset:1024 lds
    s_waitcnt vmcnt(4)
    s_barrier
    v_add_u32 v7, 16384, v6
    v_add_u32 v24, 32768, v16
    v_add_u32 v25, 32768, v17
    v_add_u32 v26, 32768, v18
    v_add_u32 v27, 32768, v19
    ds_read_b64_tr_b16 v[88:89], v7 offset:0
    ds_read_b64_tr_b16 v[90:91], v7 offset:512
    ds_read_b128 v[92:95], v24
    ds_read_b64_tr_b16 v[96:97], v7 offset:2048
    ds_read_b64_tr_b16 v[98:99], v7 offset:2560
    ds_read_b128 v[100:103], v25
    ds_read_b64_tr_b16 v[108:109], v7 offset:4096
    ds_read_b64_tr_b16 v[110:111], v7 offset:4608
    ds_read_b128 v[112:115], v26
    ds_read_b64_tr_b16 v[116:117], v7 offset:6144
    ds_read_b64_tr_b16 v[118:119], v7 offset:6656
    ds_read_b128 v[120:123], v27
    v_mfma_f32_32x32x16_bf16 v[32:47], v[48:51], v[52:55], 0
    v_mfma_f32_32x32x16_bf16 v[32:47], v[56:59], v[60:63], v[32:47]
    v_mfma_f32_32x32x16_bf16 v[32:47], v[64:67], v[68:71], v[32:47]
    v_mfma_f32_32x32x16_bf16 v[32:47], v[72:75], v[76:79], v[32:47]
    s_cmp_lg_u32 s26, 0
    s_cbranch_scc1 L_hw21
    s_and_b32 s95, s93, 14
    s_cmp_eq_u32 s95, 14
    s_cbranch_scc1 L_hp5_y
    s_mov_b64 exec, 0x3fff
    s_mov_b32 s49, 0
L_hp5:
    buffer_load_dword v127, v3, s[84:87], s99 offen sc1
    s_waitcnt vmcnt(0)
L_hp5_c:
    v_cmp_eq_u32 vcc, 1, v127
    s_add_u32 s49, s49, 1
    s_mov_b32 s93, vcc_lo
    s_and_b32 s95, vcc_lo, 14
    s_cmp_eq_u32 s95, 14
    s_cbranch_scc1 L_hp5_x
    s_cmp_gt_u32 s49, 262144
    s_cbranch_scc1 L_hp5_x
    s_sleep 2
    s_branch L_hp5
L_hp5_x:
    s_mov_b64 exec, -1
L_hp5_y:
L_hw21:
    s_waitcnt lgkmcnt(0)
    s_barrier
    s_cmp_lg_u32 s26, 0
    s_cbranch_scc1 L_hw3
    s_mov_b64 exec, 0x3fff
    buffer_load_dword v127, v3, s[84:87], s99 offen sc1
    s_mov_b64 exec, -1
L_hw3:
    s_add_u32 s97, s96, 3
    s_cmp_ge_u32 s97, 14
    s_cselect_b32 s98, 14, 0
    s_sub_u32 s97, s97, s98
    s_mul_i32 s97, s97, 256
    s_add_u32 m0, s26, 16384
    s_add_u32 s48, s23, s97
    buffer_load_dwordx4 v106, s[44:47], s48 offen lds
    buffer_load_dwordx4 v107, s[44:47], s48 offen offset:1024 lds
    s_add_u32 s97, s96, 4
    s_cmp_ge_u32 s97, 14
    s_cselect_b32 s98, 14, 0
    s_sub_u32 s97, s97, s98
    s_mul_i32 s97, s97, 114688
    s_add_u32 m0, s26, 32768
    s_add_u32 s48, s22, s97
    buffer_load_dwordx4 v104, s[56:59], s48 offen lds
    buffer_load_dwordx4 v105, s[56:59], s48 offen offset:1024 lds
    s_waitcnt vmcnt(6)
    s_barrier
    v_add_u32 v7, 49152, v6
    v_add_u32 v24, 65536, v16
    v_add_u32 v25, 65536, v17
    v_add_u32 v26, 65536, v18
    v_add_u32 v27, 65536, v19
    ds_read_b64_tr_b16 v[48:49], v7 offset:0
    ds_read_b64_tr_b16 v[50:51], v7 offset:512
    ds_read_b128 v[52:55], v24
    ds_read_b64_tr_b16 v[56:57], v7 offset:2048
    ds_read_b64_tr_b16 v[58:59], v7 offset:2560
    ds_read_b128 v[60:63], v25
    ds_read_b64_tr_b16 v[64:65], v7 offset:4096
    ds_read_b64_tr_b16 v[66:67], v7 offset:4608
    ds_read_b128 v[68:71], v26
    ds_read_b64_tr_b16 v[72:73], v7 offset:6144
    ds_read_b64_tr_b16 v[74:75], v7 offset:6656
    ds_read_b128 v[76:79], v27
    v_mfma_f32_32x32x16_bf16 v[32:47], v[88:91], v[92:95], v[32:47]
    v_mfma_f32_32x32x16_bf16 v[32:47], v[96:99], v[100:103], v[32:47]
    v_mfma_f32_32x32x16_bf16 v[32:47], v[108:111], v[112:115], v[32:47]
    v_mfma_f32_32x32x16_bf16 v[32:47], v[116:119], v[120:123], v[32:47]
    s_cmp_lg_u32 s26, 0
    s_cbranch_scc1 L_hw22
    s_and_b32 s95, s93, 16382
    s_cmp_eq_u32 s95, 16382
    s_cbranch_scc1 L_hp6_y
    s_mov_b64 exec, 0x3fff
    s_mov_b32 s49, 0
    s_waitcnt vmcnt(4)
    s_branch L_hp6_c
L_hp6:
    buffer_load_dword v127, v3, s[84:87], s99 offen sc1
    s_waitcnt vmcnt(0)
L_hp6_c:
    v_cmp_eq_u32 vcc, 1, v127
    s_add_u32 s49, s49, 1
    s_mov_b32 s93, vcc_lo
    s_and_b32 s95, vcc_lo, 16382
    s_cmp_eq_u32 s95, 16382
    s_cbranch_scc1 L_hp6_x
    s_cmp_gt_u32 s49, 262144
    s_cbranch_scc1 L_hp6_x
    s_sleep 2
    s_branch L_hp6
L_hp6_x:
    s_mov_b64 exec, -1
L_hp6_y:
L_hw22:
    s_waitcnt lgkmcnt(0)
    s_barrier
    s_add_u32 s97, s96, 4
    s_cmp_ge_u32 s97, 14
    s_cselect_b32 s98, 14, 0
    s_sub_u32 s97, s97, s98
    s_mul_i32 s97, s97, 256
    s_add_u32 m0, s26, 49152
    s_add_u32 s48, s23, s97
    buffer_load_dwordx4 v106, s[44:47], s48 offen lds
    buffer_load_dwordx4 v107, s[44:47], s48 offen offset:1024 lds
    s_add_u32 s97, s96, 5
    s_cmp_ge_u32 s97, 14
    s_cselect_b32 s98, 14, 0
    s_sub_u32 s97, s97, s98
    s_mul_i32 s97, s97, 114688
    s_add_u32 m0, s26, 65536
    s_add_u32 s48, s22, s97
    buffer_load_dwordx4 v104, s[56:59], s48 offen lds
    buffer_load_dwordx4 v105, s[56:59], s48 offen offset:1024 lds
    s_waitcnt vmcnt(6)
    s_barrier
    v_add_u32 v7, 0, v6
    v_add_u32 v24, 16384, v16
    v_add_u32 v25, 16384, v17
    v_add_u32 v26, 16384, v18
    v_add_u32 v27, 16384, v19
    ds_read_b64_tr_b16 v[88:89], v7 offset:0
    ds_read_b64_tr_b16 v[90:91], v7 offset:512
    ds_read_b128 v[92:95], v24
    ds_read_b64_tr_b16 v[96:97], v7 offset:2048
    ds_read_b64_tr_b16 v[98:99], v7 offset:2560
    ds_read_b128 v[100:103], v25
    ds_read_b64_tr_b16 v[108:109], v7 offset:4096
    ds_read_b64_tr_b16 v[110:111], v7 offset:4608
    ds_read_b128 v[112:115], v26
    ds_read_b64_tr_b16 v[116:117], v7 offset:6144
    ds_read_b64_tr_b16 v[118:119], v7 offset:6656
    ds_read_b128 v[120:123], v27
    v_mfma_f32_32x32x16_bf16 v[32:47], v[48:51], v[52:55], v[32:47]
    v_mfma_f32_32x32x16_bf16 v[32:47], v[56:59], v[60:63], v[32:47]
    v_mfma_f32_32x32x16_bf16 v[32:47], v[64:67], v[68:71], v[32:47]
    v_mfma_f32_32x32x16_bf16 v[32:47], v[72:75], v[76:79], v[32:47]
    s_waitcnt lgkmcnt(0)
    s_barrier
    s_add_u32 s97, s96, 5
    s_cmp_ge_u32 s97, 14
    s_cselect_b32 s98, 14, 0
    s_sub_u32 s97, s97, s98
    s_mul_i32 s97, s97, 256
    s_add_u32 m0, s26, 0
    s_add_u32 s48, s23, s97
    buffer_load_dwordx4 v106, s[44:47], s48 offen lds
    buffer_load_dwordx4 v107, s[44:47], s48 offen offset:1024 lds
    s_add_u32 s97, s96, 6
    s_cmp_ge_u32 s97, 14
    s_cselect_b32 s98, 14, 0
    s_sub_u32 s97, s97, s98
    s_mul_i32 s97, s97, 114688
    s_add_u32 m0, s26, 16384
    s_add_u32 s48, s22, s97
    buffer_load_dwordx4 v104, s[56:59], s48 offen lds
    buffer_load_dwordx4 v105, s[56:59], s48 offen offset:1024 lds
    s_waitcnt vmcnt(6)
    s_barrier
    v_add_u32 v7, 32768, v6
    v_add_u32 v24, 49152, v16
    v_add_u32 v25, 49152, v17
    v_add_u32 v26, 49152, v18
    v_add_u32 v27, 49152, v19
    ds_read_b64_tr_b16 v[48:49], v7 offset:0
    ds_read_b64_tr_b16 v[50:51], v7 offset:512
    ds_read_b128 v[52:55], v24
    ds_read_b64_tr_b16 v[56:57], v7 offset:2048
    ds_read_b64_tr_b16 v[58:59], v7 offset:2560
    ds_read_b128 v[60:63], v25
    ds_read_b64_tr_b16 v[64:65], v7 offset:4096
    ds_read_b64_tr_b16 v[66:67], v7 offset:4608
    ds_read_b128 v[68:71], v26
    ds_read_b64_tr_b16 v[72:73], v7 offset:6144
    ds_read_b64_tr_b16 v[74:75], v7 offset:6656
    ds_read_b128 v[76:79], v27
    v_mfma_f32_32x32x16_bf16 v[32:47], v[88:91], v[92:95], v[32:47]
    v_mfma_f32_32x32x16_bf16 v[32:47], v[96:99], v[100:103], v[32:47]
    v_mfma_f32_32x32x16_bf16 v[32:47], v[108:111], v[112:115], v[32:47]
    v_mfma_f32_32x32x16_bf16 v[32:47], v[116:119], v[120:123], v[32:47]
    s_waitcnt lgkmcnt(0)
    s_barrier
    s_add_u32 s97, s96, 6
    s_cmp_ge_u32 s97, 14
    s_cselect_b32 s98, 14, 0
    s_sub_u32 s97, s97, s98
    s_mul_i32 s97, s97, 256
    s_add_u32 m0, s26, 32768
    s_add_u32 s48, s23, s97
    buffer_load_dwordx4 v106, s[44:47], s48 offen lds
    buffer_load_dwordx4 v107, s[44:47], s48 offen offset:1024 lds
    s_add_u32 s97, s96, 7
    s_cmp_ge_u32 s97, 14
    s_cselect_b32 s98, 14, 0
    s_sub_u32 s97, s97, s98
    s_mul_i32 s97, s97, 114688
    s_add_u32 m0, s26, 49152
    s_add_u32 s48, s22, s97
    buffer_load_dwordx4 v104, s[56:59], s48 offen lds
    buffer_load_dwordx4 v105, s[56:59], s48 offen offset:1024 lds
    s_waitcnt vmcnt(6)
    s_barrier
    v_add_u32 v7, 65536, v6
    v_add_u32 v24, 0, v16
    v_add_u32 v25, 0, v17
    v_add_u32 v26, 0, v18
    v_add_u32 v27, 0, v19
    ds_read_b64_tr_b16 v[88:89], v7 offset:0
    ds_read_b64_tr_b16 v[90:91], v7 offset:512
    ds_read_b128 v[92:95], v24
    ds_read_b64_tr_b16 v[96:97], v7 offset:2048
    ds_read_b64_tr_b16 v[98:99], v7 offset:2560
    ds_read_b128 v[100:103], v25
    ds_read_b64_tr_b16 v[108:109], v7 offset:4096
    ds_read_b64_tr_b16 v[110:111], v7 offset:4608
    ds_read_b128 v[112:115], v26
    ds_read_b64_tr_b16 v[116:117], v7 offset:6144
    ds_read_b64_tr_b16 v[118:119], v7 offset:6656
    ds_read_b128 v[120:123], v27
    v_mfma_f32_32x32x16_bf16 v[32:47], v[48:51], v[52:55], v[32:47]
    v_mfma_f32_32x32x16_bf16 v[32:47], v[56:59], v[60:63], v[32:47]
    v_mfma_f32_32x32x16_bf16 v[32:47], v[64:67], v[68:71], v[32:47]
    v_mfma_f32_32x32x16_bf16 v[32:47], v[72:75], v[76:79], v[32:47]
    s_waitcnt lgkmcnt(0)
    s_barrier
    s_add_u32 s97, s96, 7
    s_cmp_ge_u32 s97, 14
    s_cselect_b32 s98, 14, 0
    s_sub_u32 s97, s97, s98
    s_mul_i32 s97, s97, 256
    s_add_u32 m0, s26, 65536
    s_add_u32 s48, s23, s97
    buffer_load_dwordx4 v106, s[44:47], s48 offen lds
    buffer_load_dwordx4 v107, s[44:47], s48 offen offset:1024 lds
    s_add_u32 s97, s96, 8
    s_cmp_ge_u32 s97, 14
    s_cselect_b32 s98, 14, 0
    s_sub_u32 s97, s97, s98
    s_mul_i32 s97, s97, 114688
    s_add_u32 m0, s26, 0
    s_add_u32 s48, s22, s97
    buffer_load_dwordx4 v104, s[56:59], s48 offen lds
    buffer_load_dwordx4 v105, s[56:59], s48 offen offset:1024 lds
    s_waitcnt vmcnt(6)
    s_barrier
    v_add_u32 v7, 16384, v6
    v_add_u32 v24, 32768, v16
    v_add_u32 v25, 32768, v17
    v_add_u32 v26, 32768, v18
    v_add_u32 v27, 32768, v19
    ds_read_b64_tr_b16 v[48:49], v7 offset:0
    ds_read_b64_tr_b16 v[50:51], v7 offset:512
    ds_read_b128 v[52:55], v24
    ds_read_b64_tr_b16 v[56:57], v7 offset:2048
    ds_read_b64_tr_b16 v[58:59], v7 offset:2560
    ds_read_b128 v[60:63], v25
    ds_read_b64_tr_b16 v[64:65], v7 offset:4096
    ds_read_b64_tr_b16 v[66:67], v7 offset:4608
    ds_read_b128 v[68:71], v26
    ds_read_b64_tr_b16 v[72:73], v7 offset:6144
    ds_read_b64_tr_b16 v[74:75], v7 offset:6656
    ds_read_b128 v[76:79], v27
    v_mfma_f32_32x32x16_bf16 v[32:47], v[88:91], v[92:95], v[32:47]
    v_mfma_f32_32x32x16_bf16 v[32:47], v[96:99], v[100:103], v[32:47]
    v_mfma_f32_32x32x16_bf16 v[32:47], v[108:111], v[112:115], v[32:47]
    v_mfma_f32_32x32x16_bf16 v[32:47], v[116:119], v[120:123], v[32:47]
    s_waitcnt lgkmcnt(0)
    s_barrier
    s_add_u32 s97, s96, 8
    s_cmp_ge_u32 s97, 14
    s_cselect_b32 s98, 14, 0
    s_sub_u32 s97, s97, s98
    s_mul_i32 s97, s97, 256
    s_add_u32 m0, s26, 16384
    s_add_u32 s48, s23, s97
    buffer_load_dwordx4 v106, s[44:47], s48 offen lds
    buffer_load_dwordx4 v107, s[44:47], s48 offen offset:1024 lds
    s_add_u32 s97, s96, 9
    s_cmp_ge_u32 s97, 14
    s_cselect_b32 s98, 14, 0
    s_sub_u32 s97, s97, s98
    s_mul_i32 s97, s97, 114688
    s_add_u32 m0, s26, 32768
    s_add_u32 s48, s22, s97
    buffer_load_dwordx4 v104, s[56:59], s48 offen lds
    buffer_load_dwordx4 v105, s[56:59], s48 offen offset:1024 lds
    s_waitcnt vmcnt(6)
    s_barrier
    v_add_u32 v7, 49152, v6
    v_add_u32 v24, 65536, v16
    v_add_u32 v25, 65536, v17
    v_add_u32 v26, 65536, v18
    v_add_u32 v27, 65536, v19
    ds_read_b64_tr_b16 v[88:89], v7 offset:0
    ds_read_b64_tr_b16 v[90:91], v7 offset:512
    ds_read_b128 v[92:95], v24
    ds_read_b64_tr_b16 v[96:97], v7 offset:2048
    ds_read_b64_tr_b16 v[98:99], v7 offset:2560
    ds_read_b128 v[100:103], v25
    ds_read_b64_tr_b16 v[108:109], v7 offset:4096
    ds_read_b64_tr_b16 v[110:111], v7 offset:4608
    ds_read_b128 v[112:115], v26
    ds_read_b64_tr_b16 v[116:117], v7 offset:6144
    ds_read_b64_tr_b16 v[118:119], v7 offset:6656
    ds_read_b128 v[120:123], v27
    v_mfma_f32_32x32x16_bf16 v[32:47], v[48:51], v[52:55], v[32:47]
    v_mfma_f32_32x32x16_bf16 v[32:47], v[56:59], v[60:63], v[32:47]
    v_mfma_f32_32x32x16_bf16 v[32:47], v[64:67], v[68:71], v[32:47]
    v_mfma_f32_32x32x16_bf16 v[32:47], v[72:75], v[76:79], v[32:47]
    s_waitcnt lgkmcnt(0)
    s_barrier
    s_add_u32 s97, s96, 9
    s_cmp_ge_u32 s97, 14
    s_cselect_b32 s98, 14, 0
    s_sub_u32 s97, s97, s98
    s_mul_i32 s97, s97, 256
    s_add_u32 m0, s26, 49152
    s_add_u32 s48, s23, s97
    buffer_load_dwordx4 v106, s[44:47], s48 offen lds
    buffer_load_dwordx4 v107, s[44:47], s48 offen offset:1024 lds
    s_add_u32 s97, s96, 10
    s_cmp_ge_u32 s97, 14
    s_cselect_b32 s98, 14, 0
    s_sub_u32 s97, s97, s98
    s_mul_i32 s97, s97, 114688
    s_add_u32 m0, s26, 65536
    s_add_u32 s48, s22, s97
    buffer_load_dwordx4 v104, s[56:59], s48 offen lds
    buffer_load_dwordx4 v105, s[56:59], s48 offen offset:1024 lds
    s_waitcnt vmcnt(6)
    s_barrier
    v_add_u32 v7, 0, v6
    v_add_u32 v24, 16384, v16
    v_add_u32 v25, 16384, v17
    v_add_u32 v26, 16384, v18
    v_add_u32 v27, 16384, v19
    ds_read_b64_tr_b16 v[48:49], v7 offset:0
    ds_read_b64_tr_b16 v[50:51], v7 offset:512
    ds_read_b128 v[52:55], v24
    ds_read_b64_tr_b16 v[56:57], v7 offset:2048
    ds_read_b64_tr_b16 v[58:59], v7 offset:2560
    ds_read_b128 v[60:63], v25
    ds_read_b64_tr_b16 v[64:65], v7 offset:4096
    ds_read_b64_tr_b16 v[66:67], v7 offset:4608
    ds_read_b128 v[68:71], v26
    ds_read_b64_tr_b16 v[72:73], v7 offset:6144
    ds_read_b64_tr_b16 v[74:75], v7 offset:6656
    ds_read_b128 v[76:79], v27
    v_mfma_f32_32x32x16_bf16 v[32:47], v[88:91], v[92:95], v[32:47]
    v_mfma_f32_32x32x16_bf16 v[32:47], v[96:99], v[100:103], v[32:47]
    v_mfma_f32_32x32x16_bf16 v[32:47], v[108:111], v[112:115], v[32:47]
    v_mfma_f32_32x32x16_bf16 v[32:47], v[116:119], v[120:123], v[32:47]
    s_waitcnt lgkmcnt(0)
    s_barrier
    s_add_u32 s97, s96, 10
    s_cmp_ge_u32 s97, 14
    s_cselect_b32 s98, 14, 0
    s_sub_u32 s97, s97, s98
    s_mul_i32 s97, s97, 256
    s_add_u32 m0, s26, 0
    s_add_u32 s48, s23, s97
    buffer_load_dwordx4 v106, s[44:47], s48 offen lds
    buffer_load_dwordx4 v107, s[44:47], s48 offen offset:1024 lds
    s_add_u32 s97, s96, 11
    s_cmp_ge_u32 s97, 14
    s_cselect_b32 s98, 14, 0
    s_sub_u32 s97, s97, s98
    s_mul_i32 s97, s97, 114688
    s_add_u32 m0, s26, 16384
    s_add_u32 s48, s22, s97
    buffer_load_dwordx4 v104, s[56:59], s48 offen lds
    buffer_load_dwordx4 v105, s[56:59], s48 offen offset:1024 lds
    s_waitcnt vmcnt(6)
    s_barrier
    v_add_u32 v7, 32768, v6
    v_add_u32 v24, 49152, v16
    v_add_u32 v25, 49152, v17
    v_add_u32 v26, 49152, v18
    v_add_u32 v27, 49152, v19
    ds_read_b64_tr_b16 v[88:89], v7 offset:0
    ds_read_b64_tr_b16 v[90:91], v7 offset:512
    ds_read_b128 v[92:95], v24
    ds_read_b64_tr_b16 v[96:97], v7 offset:2048
    ds_read_b64_tr_b16 v[98:99], v7 offset:2560
    ds_read_b128 v[100:103], v25
    ds_read_b64_tr_b16 v[108:109], v7 offset:4096
    ds_read_b64_tr_b16 v[110:111], v7 offset:4608
    ds_read_b128 v[112:115], v26
    ds_read_b64_tr_b16 v[116:117], v7 offset:6144
    ds_read_b64_tr_b16 v[118:119], v7 offset:6656
    ds_read_b128 v[120:123], v27
    v_mfma_f32_32x32x16_bf16 v[32:47], v[48:51], v[52:55], v[32:47]
    v_mfma_f32_32x32x16_bf16 v[32:47], v[56:59], v[60:63], v[32:47]
    v_mfma_f32_32x32x16_bf16 v[32:47], v[64:67], v[68:71], v[32:47]
    v_mfma_f32_32x32x16_bf16 v[32:47], v[72:75], v[76:79], v[32:47]
    s_waitcnt lgkmcnt(0)
    s_barrier
    s_add_u32 s97, s96, 11
    s_cmp_ge_u32 s97, 14
    s_cselect_b32 s98, 14, 0
    s_sub_u32 s97, s97, s98
    s_mul_i32 s97, s97, 256
    s_add_u32 m0, s26, 32768
    s_add_u32 s48, s23, s97
    buffer_load_dwordx4 v106, s[44:47], s48 offen lds
    buffer_load_dwordx4 v107, s[44:47], s48 offen offset:1024 lds
    s_add_u32 s97, s96, 12
    s_cmp_ge_u32 s97, 14
    s_cselect_b32 s98, 14, 0
    s_sub_u32 s97, s97, s98
    s_mul_i32 s97, s97, 114688
    s_add_u32 m0, s26, 49152
    s_add_u32 s48, s22, s97
    buffer_load_dwordx4 v104, s[56:59], s48 offen lds
    buffer_load_dwordx4 v105, s[56:59], s48 offen offset:1024 lds
    s_waitcnt vmcnt(6)
    s_barrier
    v_add_u32 v7, 65536, v6
    v_add_u32 v24, 0, v16
    v_add_u32 v25, 0, v17
    v_add_u32 v26, 0, v18
    v_add_u32 v27, 0, v19
    ds_read_b64_tr_b16 v[48:49], v7 offset:0
    ds_read_b64_tr_b16 v[50:51], v7 offset:512
    ds_read_b128 v[52:55], v24
    ds_read_b64_tr_b16 v[56:57], v7 offset:2048
    ds_read_b64_tr_b16 v[58:59], v7 offset:2560
    ds_read_b128 v[60:63], v25
    ds_read_b64_tr_b16 v[64:65], v7 offset:4096
    ds_read_b64_tr_b16 v[66:67], v7 offset:4608
    ds_read_b128 v[68:71], v26
    ds_read_b64_tr_b16 v[72:73], v7 offset:6144
    ds_read_b64_tr_b16 v[74:75], v7 offset:6656
    ds_read_b128 v[76:79], v27
    v_mfma_f32_32x32x16_bf16 v[32:47], v[88:91], v[92:95], v[32:47]
    v_mfma_f32_32x32x16_bf16 v[32:47], v[96:99], v[100:103], v[32:47]
    v_mfma_f32_32x32x16_bf16 v[32:47], v[108:111], v[112:115], v[32:47]
    v_mfma_f32_32x32x16_bf16 v[32:47], v[116:119], v[120:123], v[32:47]
    s_waitcnt lgkmcnt(0)
    s_barrier
    s_add_u32 s97, s96, 12
    s_cmp_ge_u32 s97, 14
    s_cselect_b32 s98, 14, 0
    s_sub_u32 s97, s97, s98
    s_mul_i32 s97, s97, 256
    s_add_u32 m0, s26, 65536
    s_add_u32 s48, s23, s97
    buffer_load_dwordx4 v106, s[44:47], s48 offen lds
    buffer_load_dwordx4 v107, s[44:47], s48 offen offset:1024 lds
    s_add_u32 s97, s96, 13
    s_cmp_ge_u32 s97, 14
    s_cselect_b32 s98, 14, 0
    s_sub_u32 s97, s97, s98
    s_mul_i32 s97, s97, 114688
    s_add_u32 m0, s26, 0
    s_add_u32 s48, s22, s97
    buffer_load_dwordx4 v104, s[56:59], s48 offen lds
    buffer_load_dwordx4 v105, s[56:59], s48 offen offset:1024 lds
    s_waitcnt vmcnt(6)
    s_barrier
    v_add_u32 v7, 16384, v6
    v_add_u32 v24, 32768, v16
    v_add_u32 v25, 32768, v17
    v_add_u32 v26, 32768, v18
    v_add_u32 v27, 32768, v19
    ds_read_b64_tr_b16 v[88:89], v7 offset:0
    ds_read_b64_tr_b16 v[90:91], v7 offset:512
    ds_read_b128 v[92:95], v24
    ds_read_b64_tr_b16 v[96:97], v7 offset:2048
    ds_read_b64_tr_b16 v[98:99], v7 offset:2560
    ds_read_b128 v[100:103], v25
    ds_read_b64_tr_b16 v[108:109], v7 offset:4096
    ds_read_b64_tr_b16 v[110:111], v7 offset:4608
    ds_read_b128 v[112:115], v26
    ds_read_b64_tr_b16 v[116:117], v7 offset:6144
    ds_read_b64_tr_b16 v[118:119], v7 offset:6656
    ds_read_b128 v[120:123], v27
    v_mfma_f32_32x32x16_bf16 v[32:47], v[48:51], v[52:55], v[32:47]
    v_mfma_f32_32x32x16_bf16 v[32:47], v[56:59], v[60:63], v[32:47]
    v_mfma_f32_32x32x16_bf16 v[32:47], v[64:67], v[68:71], v[32:47]
    v_mfma_f32_32x32x16_bf16 v[32:47], v[72:75], v[76:79], v[32:47]
    s_cmp_eq_u32 s94, 32
    s_cselect_b32 s95, 1, s26
    s_cmp_lg_u32 s95, 0
    s_cbranch_scc1 L_w7_d
    s_mov_b64 exec, 0x1
    v_lshlrev_b32 v126, 8, v0
    v_mov_b32 v124, 0
    s_mov_b32 s49, 0
L_w7:
    buffer_load_dword v127, v126, s[84:87], s92 offen offset:0 sc1
    s_add_u32 s49, s49, 1
    s_waitcnt vmcnt(0)
    v_cmp_ne_u32 vcc, 32, v127
    s_cmp_gt_u32 s49, 262144
    s_cbranch_scc1 L_w7_x
    s_cbranch_vccz L_w7_x
    s_sleep 2
    s_branch L_w7
L_w7_x:
    s_mov_b64 exec, -1
L_w7_d:
    s_waitcnt lgkmcnt(0)
    s_barrier
    s_add_u32 s97, s96, 13
    s_cmp_ge_u32 s97, 14
    s_cselect_b32 s98, 14, 0
    s_sub_u32 s97, s97, s98
    s_mul_i32 s97, s97, 256
    s_add_u32 m0, s26, 16384
    s_add_u32 s48, s23, s97
    buffer_load_dwordx4 v106, s[44:47], s48 offen lds
    buffer_load_dwordx4 v107, s[44:47], s48 offen offset:1024 lds
    s_lshr_b32 s42, s26, 1
    s_add_u32 m0, s42, 32768
    s_nop 0
    buffer_load_dwordx4 v8, s[32:35], s24 offen lds
    s_waitcnt vmcnt(5)
    s_barrier
    v_add_u32 v7, 49152, v6
    v_add_u32 v24, 65536, v16
    v_add_u32 v25, 65536, v17
    v_add_u32 v26, 65536, v18
    v_add_u32 v27, 65536, v19
    ds_read_b64_tr_b16 v[48:49], v7 offset:0
    ds_read_b64_tr_b16 v[50:51], v7 offset:512
    ds_read_b128 v[52:55], v24
    ds_read_b64_tr_b16 v[56:57], v7 offset:2048
    ds_read_b64_tr_b16 v[58:59], v7 offset:2560
    ds_read_b128 v[60:63], v25
    ds_read_b64_tr_b16 v[64:65], v7 offset:4096
    ds_read_b64_tr_b16 v[66:67], v7 offset:4608
    ds_read_b128 v[68:71], v26
    ds_read_b64_tr_b16 v[72:73], v7 offset:6144
    ds_read_b64_tr_b16 v[74:75], v7 offset:6656
    ds_read_b128 v[76:79], v27
    v_mfma_f32_32x32x16_bf16 v[32:47], v[88:91], v[92:95], v[32:47]
    v_mfma_f32_32x32x16_bf16 v[32:47], v[96:99], v[100:103], v[32:47]
    v_mfma_f32_32x32x16_bf16 v[32:47], v[108:111], v[112:115], v[32:47]
    v_mfma_f32_32x32x16_bf16 v[32:47], v[116:119], v[120:123], v[32:47]
    s_waitcnt lgkmcnt(0)
    s_waitcnt vmcnt(0)
    s_barrier
    v_add_u32 v7, 0, v6
    v_add_u32 v24, 16384, v16
    v_add_u32 v25, 16384, v17
    v_add_u32 v26, 16384, v18
    v_add_u32 v27, 16384, v19
    ds_read_b64_tr_b16 v[88:89], v7 offset:0
    ds_read_b64_tr_b16 v[90:91], v7 offset:512
    ds_read_b128 v[92:95], v24
    ds_read_b64_tr_b16 v[96:97], v7 offset:2048
    ds_read_b64_tr_b16 v[98:99], v7 offset:2560
    ds_read_b128 v[100:103], v25
    ds_read_b64_tr_b16 v[108:109], v7 offset:4096
    ds_read_b64_tr_b16 v[110:111], v7 offset:4608
    ds_read_b128 v[112:115], v26
    ds_read_b64_tr_b16 v[116:117], v7 offset:6144
    ds_read_b64_tr_b16 v[118:119], v7 offset:6656
    ds_read_b128 v[120:123], v27
    v_mfma_f32_32x32x16_bf16 v[32:47], v[48:51], v[52:55], v[32:47]
    v_mfma_f32_32x32x16_bf16 v[32:47], v[56:59], v[60:63], v[32:47]
    v_mfma_f32_32x32x16_bf16 v[32:47], v[64:67], v[68:71], v[32:47]
    v_mfma_f32_32x32x16_bf16 v[32:47], v[72:75], v[76:79], v[32:47]
    s_waitcnt lgkmcnt(9)
    v_mfma_f32_32x32x16_bf16 v[32:47], v[88:91], v[92:95], v[32:47]
    s_waitcnt lgkmcnt(6)
    v_mfma_f32_32x32x16_bf16 v[32:47], v[96:99], v[100:103], v[32:47]
    s_waitcnt lgkmcnt(3)
    v_mfma_f32_32x32x16_bf16 v[32:47], v[108:111], v[112:115], v[32:47]
    s_waitcnt lgkmcnt(0)
    v_mfma_f32_32x32x16_bf16 v[32:47], v[116:119], v[120:123], v[32:47]
    ds_read_u16 v72, v29 offset:0
    ds_read_u16 v73, v29 offset:128
    ds_read_u16 v74, v29 offset:256
    ds_read_u16 v75, v29 offset:384
    ds_read_u16 v76, v29 offset:1024
    ds_read_u16 v77, v29 offset:1152
    ds_read_u16 v78, v29 offset:1280
    ds_read_u16 v79, v29 offset:1408
    v_lshlrev_b32 v64, 16, v80
    v_and_b32 v65, 0xffff0000, v80
    v_lshlrev_b32 v66, 16, v81
    v_and_b32 v67, 0xffff0000, v81
    v_lshlrev_b32 v68, 16, v82
    v_and_b32 v69, 0xffff0000, v82
    v_lshlrev_b32 v70, 16, v83
    v_and_b32 v71, 0xffff0000, v83
    s_waitcnt lgkmcnt(0)
    v_lshlrev_b32 v72, 16, v72
    v_add_f32 v64, v64, v72
    v_lshlrev_b32 v73, 16, v73
    v_add_f32 v65, v65, v73
    v_lshlrev_b32 v74, 16, v74
    v_add_f32 v66, v66, v74
    v_lshlrev_b32 v75, 16, v75
    v_add_f32 v67, v67, v75
    v_lshlrev_b32 v76, 16, v76
    v_add_f32 v68, v68, v76
    v_lshlrev_b32 v77, 16, v77
    v_add_f32 v69, v69, v77
    v_lshlrev_b32 v78, 16, v78
    v_add_f32 v70, v70, v78
    v_lshlrev_b32 v79, 16, v79
    v_add_f32 v71, v71, v79
    v_cvt_pk_bf16_f32 v80, v64, v65
    v_lshlrev_b32 v64, 16, v80
    v_and_b32 v65, 0xffff0000, v80
    v_cvt_pk_bf16_f32 v81, v66, v67
    v_lshlrev_b32 v66, 16, v81
    v_and_b32 v67, 0xffff0000, v81
    v_cvt_pk_bf16_f32 v82, v68, v69
    v_lshlrev_b32 v68, 16, v82
    v_and_b32 v69, 0xffff0000, v82
    v_cvt_pk_bf16_f32 v83, v70, v71
    v_lshlrev_b32 v70, 16, v83
    v_and_b32 v71, 0xffff0000, v83
    s_cmp_lt_u32 s26, 8192
    s_cbranch_scc0 L_fin_g1
    ds_write_b128 v9, v[40:43]
    ds_write_b128 v9, v[44:47] offset:4096
    s_branch L_fin_j
L_fin_g1:
    ds_write_b128 v9, v[32:35]
    ds_write_b128 v9, v[36:39] offset:4096
    s_nop 1
    v_mov_b32 v32, v40
    v_mov_b32 v33, v41
    v_mov_b32 v34, v42
    v_mov_b32 v35, v43
    v_mov_b32 v36, v44
    v_mov_b32 v37, v45
    v_mov_b32 v38, v46
    v_mov_b32 v39, v47
L_fin_j:
    s_waitcnt lgkmcnt(0)
    s_barrier
    ds_read_b128 v[48:51], v15
    ds_read_b128 v[52:55], v15 offset:4096
    s_waitcnt lgkmcnt(0)
    v_add_f32 v32, v32, v48
    v_add_f32 v33, v33, v49
    v_cvt_pk_bf16_f32 v60, v32, v33
    v_lshlrev_b32 v32, 16, v60
    v_and_b32 v33, 0xffff0000, v60
    v_lshlrev_b32 v61, 16, v84
    v_and_b32 v62, 0xffff0000, v84
    v_add_f32 v32, v32, v61
    v_add_f32 v33, v33, v62
    v_cvt_pk_bf16_f32 v60, v32, v33
    v_lshlrev_b32 v32, 16, v60
    v_and_b32 v33, 0xffff0000, v60
    v_add_f32 v32, v32, v64
    v_add_f32 v33, v33, v65
    v_cvt_pk_bf16_f32 v56, v32, v33
    v_add_f32 v34, v34, v50
    v_add_f32 v35, v35, v51
    v_cvt_pk_bf16_f32 v60, v34, v35
    v_lshlrev_b32 v34, 16, v60
    v_and_b32 v35, 0xffff0000, v60
    v_lshlrev_b32 v61, 16, v85
    v_and_b32 v62, 0xffff0000, v85
    v_add_f32 v34, v34, v61
    v_add_f32 v35, v35, v62
    v_cvt_pk_bf16_f32 v60, v34, v35
    v_lshlrev_b32 v34, 16, v60
    v_and_b32 v35, 0xffff0000, v60
    v_add_f32 v34, v34, v66
    v_add_f32 v35, v35, v67
    v_cvt_pk_bf16_f32 v57, v34, v35
    v_add_f32 v36, v36, v52
    v_add_f32 v37, v37, v53
    v_cvt_pk_bf16_f32 v60, v36, v37
    v_lshlrev_b32 v36, 16, v60
    v_and_b32 v37, 0xffff0000, v60
    v_lshlrev_b32 v61, 16, v86
    v_and_b32 v62, 0xffff0000, v86
    v_add_f32 v36, v36, v61
    v_add_f32 v37, v37, v62
    v_cvt_pk_bf16_f32 v60, v36, v37
    v_lshlrev_b32 v36, 16, v60
    v_and_b32 v37, 0xffff0000, v60
    v_add_f32 v36, v36, v68
    v_add_f32 v37, v37, v69
    v_cvt_pk_bf16_f32 v58, v36, v37
    v_add_f32 v38, v38, v54
    v_add_f32 v39, v39, v55
    v_cvt_pk_bf16_f32 v60, v38, v39
    v_lshlrev_b32 v38, 16, v60
    v_and_b32 v39, 0xffff0000, v60
    v_lshlrev_b32 v61, 16, v87
    v_and_b32 v62, 0xffff0000, v87
    v_add_f32 v38, v38, v61
    v_add_f32 v39, v39, v62
    v_cvt_pk_bf16_f32 v60, v38, v39
    v_lshlrev_b32 v38, 16, v60
    v_and_b32 v39, 0xffff0000, v60
    v_add_f32 v38, v38, v70
    v_add_f32 v39, v39, v71
    v_cvt_pk_bf16_f32 v59, v38, v39
    s_nop 1
    v_permlane32_swap_b32 v56, v58
    v_permlane32_swap_b32 v57, v59
    buffer_store_dwordx4 v[56:59], v31, s[80:83], 0 offen
    s_branch L_done
L_ssm:
    s_load_dwordx8 s[4:11], s[0:1], 8
    s_load_dwordx4 s[12:15], s[0:1], 40
    s_load_dwordx4 s[16:19], s[0:1], 56
    s_load_dwordx4 s[20:23], s[0:1], 120
    s_load_dwordx2 s[56:57], s[0:1], 0
    v_lshrrev_b32 v1, 6, v0
    s_nop 0
    v_readfirstlane_b32 s26, v1
    s_lshl_b32 s26, s26, 11
    s_sub_u32 s3, s2, 224
    s_lshl_b32 s3, s3, 1
    s_lshr_b32 s33, s26, 13
    v_and_b32 v23, 255, v0
    s_lshl_b32 s24, s3, 9
    v_lshl_add_u32 v1, v23, 1, s24
    s_lshl_b32 s25, s3, 1
    v_mov_b32 v2, s25
    v_lshrrev_b32 v3, 2, v23
    v_and_b32 v4, 3, v0
    v_lshlrev_b32 v4, 2, v4
    v_xor_b32 v5, 0, v3
    v_lshl_add_u32 v60, v5, 4, v4
    v_xor_b32 v5, 2, v3
    v_lshl_add_u32 v61, v5, 4, v4
    v_xor_b32 v5, 4, v3
    v_lshl_add_u32 v62, v5, 4, v4
    v_xor_b32 v5, 6, v3
    v_lshl_add_u32 v63, v5, 4, v4
    v_xor_b32 v5, 8, v3
    v_lshl_add_u32 v64, v5, 4, v4
    v_xor_b32 v5, 10, v3
    v_lshl_add_u32 v65, v5, 4, v4
    v_xor_b32 v5, 12, v3
    v_lshl_add_u32 v66, v5, 4, v4
    v_xor_b32 v5, 14, v3
    v_lshl_add_u32 v67, v5, 4, v4
    s_waitcnt lgkmcnt(0)
    s_mov_b32 s52, s20
    s_mov_b32 s53, s21
    s_mov_b32 s54, 0x100
    s_mov_b32 s55, 0x00020000
    s_add_u32 s84, s22, 0x1800000
    s_addc_u32 s85, s23, 0
    s_mov_b32 s86, 0x4000
    s_mov_b32 s87, 0x00020000
    s_mov_b32 s98, 0
    s_mov_b32 s28, s16
    s_mov_b32 s29, s17
    s_mov_b32 s30, 0x380
    s_mov_b32 s31, 0x00020000
    buffer_load_ushort v102, v2, s[28:31], 0 offen offset:0
    buffer_load_ushort v110, v2, s[28:31], 0 offen offset:2
    s_mov_b32 s28, s4
    s_mov_b32 s29, s5
    s_mov_b32 s30, 0x38000
    s_mov_b32 s31, 0x00020000
    buffer_load_ushort v96, v1, s[28:31], 0 offen offset:0
    buffer_load_ushort v104, v1, s[28:31], 0 offen offset:512
    s_mov_b32 s28, s6
    s_mov_b32 s29, s7
    s_mov_b32 s30, 0x38000
    s_mov_b32 s31, 0x00020000
    buffer_load_ushort v97, v1, s[28:31], 0 offen offset:0
    buffer_load_ushort v105, v1, s[28:31], 0 offen offset:512
    s_cmp_eq_u32 s33, 0
    s_cbranch_scc1 L_ssm_ld
    s_mov_b32 s28, s8
    s_mov_b32 s29, s9
    s_mov_b32 s30, 0x38000
    s_mov_b32 s31, 0x00020000
    buffer_load_ushort v98, v1, s[28:31], 0 offen offset:0
    buffer_load_ushort v106, v1, s[28:31], 0 offen offset:512
    s_mov_b32 s28, s10
    s_mov_b32 s29, s11
    s_mov_b32 s30, 0x38000
    s_mov_b32 s31, 0x00020000
    buffer_load_ushort v99, v1, s[28:31], 0 offen offset:0
    buffer_load_ushort v107, v1, s[28:31], 0 offen offset:512
    s_mov_b32 s28, s12
    s_mov_b32 s29, s13
    s_mov_b32 s30, 0x38000
    s_mov_b32 s31, 0x00020000
    buffer_load_ushort v100, v1, s[28:31], 0 offen offset:0
    buffer_load_ushort v108, v1, s[28:31], 0 offen offset:512
    s_mov_b32 s28, s14
    s_mov_b32 s29, s15
    s_mov_b32 s30, 0x38000
    s_mov_b32 s31, 0x00020000
    buffer_load_ushort v101, v1, s[28:31], 0 offen offset:0
    buffer_load_ushort v109, v1, s[28:31], 0 offen offset:512
L_ssm_ld:
    v_and_b32 v5, 15, v0
    v_bfe_u32 v6, v0, 4, 2
    v_lshlrev_b32 v7, 1, v5
    v_and_b32 v7, 15, v7
    v_bfe_u32 v8, v0, 7, 1
    v_bfe_u32 v9, v0, 6, 1
    v_lshl_add_u32 v8, v8, 4, v5
    v_lshlrev_b32 v8, 10, v8
    v_lshl_add_u32 v17, v9, 4, v5
    v_add_u32 v17, 21, v17
    v_lshlrev_b32 v17, 10, v17
    v_or_b32 v18, 0, v6
    v_xor_b32 v18, v18, v7
    v_lshl_add_u32 v70, v18, 4, v8
    v_lshl_add_u32 v74, v18, 4, v17
    v_or_b32 v18, 4, v6
    v_xor_b32 v18, v18, v7
    v_lshl_add_u32 v71, v18, 4, v8
    v_lshl_add_u32 v75, v18, 4, v17
    v_or_b32 v18, 8, v6
    v_xor_b32 v18, v18, v7
    v_lshl_add_u32 v72, v18, 4, v8
    v_lshl_add_u32 v76, v18, 4, v17
    v_or_b32 v18, 12, v6
    v_xor_b32 v18, v18, v7
    v_lshl_add_u32 v73, v18, 4, v8
    v_lshl_add_u32 v77, v18, 4, v17
    v_lshl_add_u32 v78, v9, 4, v5
    v_lshlrev_b32 v78, 4, v78
    v_cmp_eq_u32 s[34:35], 1, v6
    v_cmp_eq_u32 s[36:37], 2, v6
    v_cmp_eq_u32 s[38:39], 3, v6
    s_bitcmp1_b32 s26, 12
    s_mov_b32 s44, 0
    s_cselect_b32 s40, 2048, s44
    s_mov_b32 s44, 8
    s_cselect_b32 s41, 4096, s44
    s_mov_b32 s44, 512
    s_cselect_b32 s42, 4608, s44
    s_mov_b32 s44, 1024
    s_cselect_b32 s43, 4608, s44
    v_mov_b32 v80, s40
    v_mov_b32 v18, s41
    v_cndmask_b32 v80, v80, v18, s[34:35]
    v_mov_b32 v18, s42
    v_cndmask_b32 v80, v80, v18, s[36:37]
    v_mov_b32 v18, s43
    v_cndmask_b32 v80, v80, v18, s[38:39]
    v_add_u32 v80, v80, v78
    s_mov_b32 s44, 2
    s_cselect_b32 s40, 2560, s44
    s_mov_b32 s44, 10
    s_cselect_b32 s41, 4608, s44
    s_mov_b32 s44, 516
    s_cselect_b32 s42, 4608, s44
    s_mov_b32 s44, 1032
    s_cselect_b32 s43, 4608, s44
    v_mov_b32 v81, s40
    v_mov_b32 v18, s41
    v_cndmask_b32 v81, v81, v18, s[34:35]
    v_mov_b32 v18, s42
    v_cndmask_b32 v81, v81, v18, s[36:37]
    v_mov_b32 v18, s43
    v_cndmask_b32 v81, v81, v18, s[38:39]
    v_add_u32 v81, v81, v78
    s_mov_b32 s44, 4
    s_cselect_b32 s40, 3072, s44
    s_mov_b32 s44, 12
    s_cselect_b32 s41, 4608, s44
    s_mov_b32 s44, 520
    s_cselect_b32 s42, 4608, s44
    s_mov_b32 s44, 1536
    s_cselect_b32 s43, 4608, s44
    v_mov_b32 v82, s40
    v_mov_b32 v18, s41
    v_cndmask_b32 v82, v82, v18, s[34:35]
    v_mov_b32 v18, s42
    v_cndmask_b32 v82, v82, v18, s[36:37]
    v_mov_b32 v18, s43
    v_cndmask_b32 v82, v82, v18, s[38:39]
    v_add_u32 v82, v82, v78
    s_mov_b32 s44, 6
    s_cselect_b32 s40, 3584, s44
    s_mov_b32 s44, 14
    s_cselect_b32 s41, 4608, s44
    s_mov_b32 s44, 524
    s_cselect_b32 s42, 4608, s44
    s_mov_b32 s44, 1544
    s_cselect_b32 s43, 4608, s44
    v_mov_b32 v83, s40
    v_mov_b32 v18, s41
    v_cndmask_b32 v83, v83, v18, s[34:35]
    v_mov_b32 v18, s42
    v_cndmask_b32 v83, v83, v18, s[36:37]
    v_mov_b32 v18, s43
    v_cndmask_b32 v83, v83, v18, s[38:39]
    v_add_u32 v83, v83, v78
    s_waitcnt vmcnt(0)
    v_lshlrev_b32 v96, 16, v96
    v_lshlrev_b32 v97, 16, v97
    v_lshlrev_b32 v102, 16, v102
    v_mul_f32 v102, 0x3fb8aa3b, v102
    v_exp_f32 v102, v102
    s_nop 0
    v_cvt_pk_bf16_f32 v18, v102, v102
    v_lshlrev_b32 v102, 16, v18
    v_mul_f32 v96, v102, v96
    v_mul_f32 v97, v102, v97
    v_mul_f32 v20, 0x3fb8aa3b, v96
    v_mul_f32 v21, 0.15915494, v97
    s_cmp_eq_u32 s33, 0
    s_cbranch_scc0 L_rows0
    v_mul_f32 v22, 0x41000000, v20
    v_mul_f32 v24, 0x41000000, v21
    v_exp_f32 v22, v22
    v_fract_f32 v24, v24
    v_cos_f32 v25, v24
    v_sin_f32 v24, v24
    s_nop 0
    v_mul_f32 v30, v22, v25
    v_mul_f32 v31, v22, v24
    v_mul_f32 v22, 0x41800000, v20
    v_mul_f32 v24, 0x41800000, v21
    v_exp_f32 v22, v22
    v_fract_f32 v24, v24
    v_cos_f32 v25, v24
    v_sin_f32 v24, v24
    s_nop 0
    v_mul_f32 v32, v22, v25
    v_mul_f32 v33, v22, v24
    v_mov_b32 v40, 1.0
    v_mov_b32 v41, 0
    v_cvt_pk_bf16_f32 v18, v40, v41
    ds_write_b32 v60, v18 offset:21504
    v_cvt_pk_bf16_f32 v19, v30, v31
    ds_write_b32 v61, v19 offset:22528
    v_cvt_pk_bf16_f32 v18, v32, v33
    ds_write_b32 v62, v18 offset:23552
    v_mul_f32 v22, v31, v33
    v_mul_f32 v24, v31, v32
    v_fma_f32 v48, v30, v32, -v22
    v_fma_f32 v49, v30, v33, v24
    v_cvt_pk_bf16_f32 v19, v48, v49
    ds_write_b32 v63, v19 offset:24576
    v_mul_f32 v22, v33, v33
    v_mul_f32 v24, v33, v32
    v_fma_f32 v42, v32, v32, -v22
    v_fma_f32 v43, v32, v33, v24
    v_cvt_pk_bf16_f32 v18, v42, v43
    ds_write_b32 v64, v18 offset:25600
    v_mul_f32 v22, v49, v33
    v_mul_f32 v24, v49, v32
    v_fma_f32 v46, v48, v32, -v22
    v_fma_f32 v47, v48, v33, v24
    v_cvt_pk_bf16_f32 v19, v46, v47
    ds_write_b32 v65, v19 offset:26624
    v_mul_f32 v22, v43, v33
    v_mul_f32 v24, v43, v32
    v_fma_f32 v44, v42, v32, -v22
    v_fma_f32 v45, v42, v33, v24
    v_cvt_pk_bf16_f32 v18, v44, v45
    ds_write_b32 v66, v18 offset:27648
    v_mul_f32 v22, v47, v33
    v_mul_f32 v24, v47, v32
    v_fma_f32 v48, v46, v32, -v22
    v_fma_f32 v49, v46, v33, v24
    v_cvt_pk_bf16_f32 v19, v48, v49
    ds_write_b32 v67, v19 offset:28672
    v_mul_f32 v22, v45, v33
    v_mul_f32 v24, v45, v32
    v_fma_f32 v42, v44, v32, -v22
    v_fma_f32 v43, v44, v33, v24
    v_cvt_pk_bf16_f32 v18, v42, v43
    ds_write_b32 v60, v18 offset:29696
    v_mul_f32 v22, v49, v33
    v_mul_f32 v24, v49, v32
    v_fma_f32 v46, v48, v32, -v22
    v_fma_f32 v47, v48, v33, v24
    v_cvt_pk_bf16_f32 v19, v46, v47
    ds_write_b32 v61, v19 offset:30720
    v_mul_f32 v22, v43, v33
    v_mul_f32 v24, v43, v32
    v_fma_f32 v44, v42, v32, -v22
    v_fma_f32 v45, v42, v33, v24
    v_cvt_pk_bf16_f32 v18, v44, v45
    ds_write_b32 v62, v18 offset:31744
    v_mul_f32 v22, v47, v33
    v_mul_f32 v24, v47, v32
    v_fma_f32 v48, v46, v32, -v22
    v_fma_f32 v49, v46, v33, v24
    v_cvt_pk_bf16_f32 v19, v48, v49
    ds_write_b32 v63, v19 offset:32768
    v_mul_f32 v22, v45, v33
    v_mul_f32 v24, v45, v32
    v_fma_f32 v42, v44, v32, -v22
    v_fma_f32 v43, v44, v33, v24
    v_cvt_pk_bf16_f32 v18, v42, v43
    ds_write_b32 v64, v18 offset:33792
    v_mul_f32 v22, v49, v33
    v_mul_f32 v24, v49, v32
    v_fma_f32 v46, v48, v32, -v22
    v_fma_f32 v47, v48, v33, v24
    v_cvt_pk_bf16_f32 v19, v46, v47
    ds_write_b32 v65, v19 offset:34816
    v_mul_f32 v22, v43, v33
    v_mul_f32 v24, v43, v32
    v_fma_f32 v44, v42, v32, -v22
    v_fma_f32 v45, v42, v33, v24
    v_cvt_pk_bf16_f32 v18, v44, v45
    ds_write_b32 v66, v18 offset:35840
    v_mul_f32 v22, v47, v33
    v_mul_f32 v24, v47, v32
    v_fma_f32 v48, v46, v32, -v22
    v_fma_f32 v49, v46, v33, v24
    v_cvt_pk_bf16_f32 v19, v48, v49
    ds_write_b32 v67, v19 offset:36864
    v_mul_f32 v22, v45, v33
    v_mul_f32 v24, v45, v32
    v_fma_f32 v42, v44, v32, -v22
    v_fma_f32 v43, v44, v33, v24
    v_cvt_pk_bf16_f32 v18, v42, v43
    ds_write_b32 v60, v18 offset:37888
    v_mul_f32 v22, v49, v33
    v_mul_f32 v24, v49, v32
    v_fma_f32 v46, v48, v32, -v22
    v_fma_f32 v47, v48, v33, v24
    v_cvt_pk_bf16_f32 v19, v46, v47
    ds_write_b32 v61, v19 offset:38912
    v_mul_f32 v22, v43, v33
    v_mul_f32 v24, v43, v32
    v_fma_f32 v44, v42, v32, -v22
    v_fma_f32 v45, v42, v33, v24
    v_cvt_pk_bf16_f32 v18, v44, v45
    ds_write_b32 v62, v18 offset:39936
    v_mul_f32 v22, v47, v33
    v_mul_f32 v24, v47, v32
    v_fma_f32 v48, v46, v32, -v22
    v_fma_f32 v49, v46, v33, v24
    v_cvt_pk_bf16_f32 v19, v48, v49
    ds_write_b32 v63, v19 offset:40960
    v_mul_f32 v22, v45, v33
    v_mul_f32 v24, v45, v32
    v_fma_f32 v42, v44, v32, -v22
    v_fma_f32 v43, v44, v33, v24
    v_cvt_pk_bf16_f32 v18, v42, v43
    ds_write_b32 v64, v18 offset:41984
    v_mul_f32 v22, v49, v33
    v_mul_f32 v24, v49, v32
    v_fma_f32 v46, v48, v32, -v22
    v_fma_f32 v47, v48, v33, v24
    v_cvt_pk_bf16_f32 v19, v46, v47
    ds_write_b32 v65, v19 offset:43008
    v_mul_f32 v22, v43, v33
    v_mul_f32 v24, v43, v32
    v_fma_f32 v44, v42, v32, -v22
    v_fma_f32 v45, v42, v33, v24
    v_cvt_pk_bf16_f32 v18, v44, v45
    ds_write_b32 v66, v18 offset:44032
    v_mul_f32 v22, v47, v33
    v_mul_f32 v24, v47, v32
    v_fma_f32 v48, v46, v32, -v22
    v_fma_f32 v49, v46, v33, v24
    v_cvt_pk_bf16_f32 v19, v48, v49
    ds_write_b32 v67, v19 offset:45056
    v_mul_f32 v22, v45, v33
    v_mul_f32 v24, v45, v32
    v_fma_f32 v42, v44, v32, -v22
    v_fma_f32 v43, v44, v33, v24
    v_cvt_pk_bf16_f32 v18, v42, v43
    ds_write_b32 v60, v18 offset:46080
    v_mul_f32 v22, v49, v33
    v_mul_f32 v24, v49, v32
    v_fma_f32 v46, v48, v32, -v22
    v_fma_f32 v47, v48, v33, v24
    v_cvt_pk_bf16_f32 v19, v46, v47
    ds_write_b32 v61, v19 offset:47104
    v_mul_f32 v22, v43, v33
    v_mul_f32 v24, v43, v32
    v_fma_f32 v44, v42, v32, -v22
    v_fma_f32 v45, v42, v33, v24
    v_cvt_pk_bf16_f32 v18, v44, v45
    ds_write_b32 v62, v18 offset:48128
    v_mul_f32 v22, v47, v33
    v_mul_f32 v24, v47, v32
    v_fma_f32 v48, v46, v32, -v22
    v_fma_f32 v49, v46, v33, v24
    v_cvt_pk_bf16_f32 v19, v48, v49
    ds_write_b32 v63, v19 offset:49152
    v_mul_f32 v22, v45, v33
    v_mul_f32 v24, v45, v32
    v_fma_f32 v42, v44, v32, -v22
    v_fma_f32 v43, v44, v33, v24
    v_cvt_pk_bf16_f32 v18, v42, v43
    ds_write_b32 v64, v18 offset:50176
    v_mul_f32 v22, v49, v33
    v_mul_f32 v24, v49, v32
    v_fma_f32 v46, v48, v32, -v22
    v_fma_f32 v47, v48, v33, v24
    v_cvt_pk_bf16_f32 v19, v46, v47
    ds_write_b32 v65, v19 offset:51200
    v_mul_f32 v22, v43, v33
    v_mul_f32 v24, v43, v32
    v_fma_f32 v44, v42, v32, -v22
    v_fma_f32 v45, v42, v33, v24
    v_cvt_pk_bf16_f32 v18, v44, v45
    ds_write_b32 v66, v18 offset:52224
    v_mul_f32 v22, v47, v33
    v_mul_f32 v24, v47, v32
    v_fma_f32 v48, v46, v32, -v22
    v_fma_f32 v49, v46, v33, v24
    v_cvt_pk_bf16_f32 v19, v48, v49
    ds_write_b32 v67, v19 offset:53248
    s_branch L_tab0
L_rows0:
    v_lshlrev_b32 v98, 16, v98
    v_lshlrev_b32 v99, 16, v99
    v_lshlrev_b32 v100, 16, v100
    v_lshlrev_b32 v101, 16, v101
    v_mul_f32 v98, v102, v98
    v_mul_f32 v99, v102, v99
    v_mul_f32 v22, v101, v99
    v_mul_f32 v24, v101, v98
    v_fma_f32 v26, v100, v98, -v22
    v_fma_f32 v27, v100, v99, v24
    v_mul_f32 v22, 0x3f800000, v20
    v_mul_f32 v24, 0x3f800000, v21
    v_exp_f32 v22, v22
    v_fract_f32 v24, v24
    v_cos_f32 v25, v24
    v_sin_f32 v24, v24
    s_nop 0
    v_mul_f32 v28, v22, v25
    v_mul_f32 v29, v22, v24
    v_mul_f32 v22, 0x43800000, v20
    v_mul_f32 v24, 0x43800000, v21
    v_exp_f32 v22, v22
    v_fract_f32 v24, v24
    v_cos_f32 v25, v24
    v_sin_f32 v24, v24
    s_nop 0
    v_mul_f32 v32, v22, v25
    v_mul_f32 v33, v22, v24
    v_mul_f32 v22, 0x44800000, v20
    v_mul_f32 v24, 0x44800000, v21
    v_exp_f32 v22, v22
    v_fract_f32 v24, v24
    v_cos_f32 v25, v24
    v_sin_f32 v24, v24
    s_nop 0
    v_mul_f32 v34, v22, v25
    v_mul_f32 v35, v22, v24
    v_cvt_pk_bf16_f32 v18, v26, -v27
    ds_write_b32 v60, v18 offset:0
    v_mul_f32 v22, v27, v29
    v_mul_f32 v24, v27, v28
    v_fma_f32 v44, v26, v28, -v22
    v_fma_f32 v45, v26, v29, v24
    v_cvt_pk_bf16_f32 v19, v44, -v45
    ds_write_b32 v61, v19 offset:1024
    v_mul_f32 v22, v45, v29
    v_mul_f32 v24, v45, v28
    v_fma_f32 v46, v44, v28, -v22
    v_fma_f32 v47, v44, v29, v24
    v_cvt_pk_bf16_f32 v18, v46, -v47
    ds_write_b32 v62, v18 offset:2048
    v_mul_f32 v22, v47, v29
    v_mul_f32 v24, v47, v28
    v_fma_f32 v44, v46, v28, -v22
    v_fma_f32 v45, v46, v29, v24
    v_cvt_pk_bf16_f32 v19, v44, -v45
    ds_write_b32 v63, v19 offset:3072
    v_mul_f32 v22, v45, v29
    v_mul_f32 v24, v45, v28
    v_fma_f32 v48, v44, v28, -v22
    v_fma_f32 v49, v44, v29, v24
    v_cvt_pk_bf16_f32 v18, v48, -v49
    ds_write_b32 v64, v18 offset:4096
    v_mul_f32 v22, v49, v29
    v_mul_f32 v24, v49, v28
    v_fma_f32 v44, v48, v28, -v22
    v_fma_f32 v45, v48, v29, v24
    v_cvt_pk_bf16_f32 v19, v44, -v45
    ds_write_b32 v65, v19 offset:5120
    v_mul_f32 v22, v45, v29
    v_mul_f32 v24, v45, v28
    v_fma_f32 v50, v44, v28, -v22
    v_fma_f32 v51, v44, v29, v24
    v_cvt_pk_bf16_f32 v18, v50, -v51
    ds_write_b32 v66, v18 offset:6144
    v_mul_f32 v22, v51, v29
    v_mul_f32 v24, v51, v28
    v_fma_f32 v44, v50, v28, -v22
    v_fma_f32 v45, v50, v29, v24
    v_cvt_pk_bf16_f32 v19, v44, -v45
    ds_write_b32 v67, v19 offset:7168
    v_mul_f32 v22, v33, v33
    v_mul_f32 v24, v33, v32
    v_fma_f32 v36, v32, v32, -v22
    v_fma_f32 v37, v32, v33, v24
    v_mul_f32 v22, v37, v33
    v_mul_f32 v24, v37, v32
    v_fma_f32 v38, v36, v32, -v22
    v_fma_f32 v39, v36, v33, v24
    v_mul_f32 v22, v27, v33
    v_mul_f32 v24, v27, v32
    v_fma_f32 v42, v26, v32, -v22
    v_fma_f32 v43, v26, v33, v24
    v_cvt_pk_bf16_f32 v18, v42, -v43
    ds_write_b32 v60, v18 offset:8192
    v_mul_f32 v22, v47, v33
    v_mul_f32 v24, v47, v32
    v_fma_f32 v44, v46, v32, -v22
    v_fma_f32 v45, v46, v33, v24
    v_cvt_pk_bf16_f32 v19, v44, -v45
    ds_write_b32 v61, v19 offset:9216
    v_mul_f32 v22, v49, v33
    v_mul_f32 v24, v49, v32
    v_fma_f32 v42, v48, v32, -v22
    v_fma_f32 v43, v48, v33, v24
    v_cvt_pk_bf16_f32 v18, v42, -v43
    ds_write_b32 v62, v18 offset:10240
    v_mul_f32 v22, v51, v33
    v_mul_f32 v24, v51, v32
    v_fma_f32 v44, v50, v32, -v22
    v_fma_f32 v45, v50, v33, v24
    v_cvt_pk_bf16_f32 v19, v44, -v45
    ds_write_b32 v63, v19 offset:11264
    v_mul_f32 v22, v27, v37
    v_mul_f32 v24, v27, v36
    v_fma_f32 v42, v26, v36, -v22
    v_fma_f32 v43, v26, v37, v24
    v_cvt_pk_bf16_f32 v18, v42, -v43
    ds_write_b32 v64, v18 offset:12288
    v_mul_f32 v22, v49, v37
    v_mul_f32 v24, v49, v36
    v_fma_f32 v44, v48, v36, -v22
    v_fma_f32 v45, v48, v37, v24
    v_cvt_pk_bf16_f32 v19, v44, -v45
    ds_write_b32 v65, v19 offset:13312
    v_mul_f32 v22, v27, v39
    v_mul_f32 v24, v27, v38
    v_fma_f32 v42, v26, v38, -v22
    v_fma_f32 v43, v26, v39, v24
    v_cvt_pk_bf16_f32 v18, v42, -v43
    ds_write_b32 v66, v18 offset:14336
    v_mul_f32 v22, v49, v39
    v_mul_f32 v24, v49, v38
    v_fma_f32 v44, v48, v38, -v22
    v_fma_f32 v45, v48, v39, v24
    v_cvt_pk_bf16_f32 v19, v44, -v45
    ds_write_b32 v67, v19 offset:15360
    v_mul_f32 v22, v27, v35
    v_mul_f32 v24, v27, v34
    v_fma_f32 v52, v26, v34, -v22
    v_fma_f32 v53, v26, v35, v24
    v_cvt_pk_bf16_f32 v18, v52, -v53
    ds_write_b32 v60, v18 offset:16384
    v_mul_f32 v22, v53, v33
    v_mul_f32 v24, v53, v32
    v_fma_f32 v42, v52, v32, -v22
    v_fma_f32 v43, v52, v33, v24
    v_cvt_pk_bf16_f32 v19, v42, -v43
    ds_write_b32 v61, v19 offset:17408
    v_mul_f32 v22, v53, v37
    v_mul_f32 v24, v53, v36
    v_fma_f32 v44, v52, v36, -v22
    v_fma_f32 v45, v52, v37, v24
    v_cvt_pk_bf16_f32 v18, v44, -v45
    ds_write_b32 v62, v18 offset:18432
    v_mul_f32 v22, v53, v39
    v_mul_f32 v24, v53, v38
    v_fma_f32 v42, v52, v38, -v22
    v_fma_f32 v43, v52, v39, v24
    v_cvt_pk_bf16_f32 v19, v42, -v43
    ds_write_b32 v63, v19 offset:19456
    v_mul_f32 v22, v53, v35
    v_mul_f32 v24, v53, v34
    v_fma_f32 v44, v52, v34, -v22
    v_fma_f32 v45, v52, v35, v24
    v_cvt_pk_bf16_f32 v18, v44, -v45
    ds_write_b32 v64, v18 offset:20480
L_tab0:
    s_waitcnt lgkmcnt(0)
    s_barrier
    s_cmp_eq_u32 s33, 0
    s_cbranch_scc0 L_nomm0
    ds_read_b128 v[26:29], v70 offset:0
    ds_read_b128 v[30:33], v74 offset:0
    ds_read_b128 v[34:37], v71 offset:0
    ds_read_b128 v[38:41], v75 offset:0
    ds_read_b128 v[42:45], v72 offset:0
    ds_read_b128 v[46:49], v76 offset:0
    ds_read_b128 v[50:53], v73 offset:0
    ds_read_b128 v[54:57], v77 offset:0
    s_waitcnt lgkmcnt(6)
    v_mfma_f32_16x16x32_bf16 v[12:15], v[26:29], v[30:33], 0
    ds_read_b128 v[26:29], v70 offset:256
    ds_read_b128 v[30:33], v74 offset:256
    s_waitcnt lgkmcnt(6)
    v_mfma_f32_16x16x32_bf16 v[12:15], v[34:37], v[38:41], v[12:15]
    ds_read_b128 v[34:37], v71 offset:256
    ds_read_b128 v[38:41], v75 offset:256
    s_waitcnt lgkmcnt(6)
    v_mfma_f32_16x16x32_bf16 v[12:15], v[42:45], v[46:49], v[12:15]
    ds_read_b128 v[42:45], v72 offset:256
    ds_read_b128 v[46:49], v76 offset:256
    s_waitcnt lgkmcnt(6)
    v_mfma_f32_16x16x32_bf16 v[12:15], v[50:53], v[54:57], v[12:15]
    ds_read_b128 v[50:53], v73 offset:256
    ds_read_b128 v[54:57], v77 offset:256
    s_waitcnt lgkmcnt(6)
    v_mfma_f32_16x16x32_bf16 v[12:15], v[26:29], v[30:33], v[12:15]
    ds_read_b128 v[26:29], v70 offset:512
    ds_read_b128 v[30:33], v74 offset:512
    s_waitcnt lgkmcnt(6)
    v_mfma_f32_16x16x32_bf16 v[12:15], v[34:37], v[38:41], v[12:15]
    ds_read_b128 v[34:37], v71 offset:512
    ds_read_b128 v[38:41], v75 offset:512
    s_waitcnt lgkmcnt(6)
    v_mfma_f32_16x16x32_bf16 v[12:15], v[42:45], v[46:49], v[12:15]
    ds_read_b128 v[42:45], v72 offset:512
    ds_read_b128 v[46:49], v76 offset:512
    s_waitcnt lgkmcnt(6)
    v_mfma_f32_16x16x32_bf16 v[12:15], v[50:53], v[54:57], v[12:15]
    ds_read_b128 v[50:53], v73 offset:512
    ds_read_b128 v[54:57], v77 offset:512
    s_waitcnt lgkmcnt(6)
    v_mfma_f32_16x16x32_bf16 v[12:15], v[26:29], v[30:33], v[12:15]
    ds_read_b128 v[26:29], v70 offset:768
    ds_read_b128 v[30:33], v74 offset:768
    s_waitcnt lgkmcnt(6)
    v_mfma_f32_16x16x32_bf16 v[12:15], v[34:37], v[38:41], v[12:15]
    ds_read_b128 v[34:37], v71 offset:768
    ds_read_b128 v[38:41], v75 offset:768
    s_waitcnt lgkmcnt(6)
    v_mfma_f32_16x16x32_bf16 v[12:15], v[42:45], v[46:49], v[12:15]
    ds_read_b128 v[42:45], v72 offset:768
    ds_read_b128 v[46:49], v76 offset:768
    s_waitcnt lgkmcnt(6)
    v_mfma_f32_16x16x32_bf16 v[12:15], v[50:53], v[54:57], v[12:15]
    ds_read_b128 v[50:53], v73 offset:768
    ds_read_b128 v[54:57], v77 offset:768
    s_waitcnt lgkmcnt(6)
    v_mfma_f32_16x16x32_bf16 v[12:15], v[26:29], v[30:33], v[12:15]
    s_waitcnt lgkmcnt(4)
    v_mfma_f32_16x16x32_bf16 v[12:15], v[34:37], v[38:41], v[12:15]
    s_waitcnt lgkmcnt(2)
    v_mfma_f32_16x16x32_bf16 v[12:15], v[42:45], v[46:49], v[12:15]
    s_waitcnt lgkmcnt(0)
    v_mfma_f32_16x16x32_bf16 v[12:15], v[50:53], v[54:57], v[12:15]
    s_nop 7
    v_cvt_pk_bf16_f32 v16, v12, v13
    v_cvt_pk_bf16_f32 v17, v14, v15
    ds_write_b16 v80, v16 offset:54272
    ds_write_b16_d16_hi v81, v16 offset:54272
    ds_write_b16 v82, v17 offset:54272
    ds_write_b16_d16_hi v83, v17 offset:54272
    s_waitcnt lgkmcnt(0)
L_nomm0:
    s_barrier
    v_lshlrev_b32 v104, 16, v104
    v_lshlrev_b32 v105, 16, v105
    v_lshlrev_b32 v110, 16, v110
    v_mul_f32 v110, 0x3fb8aa3b, v110
    v_exp_f32 v110, v110
    s_nop 0
    v_cvt_pk_bf16_f32 v18, v110, v110
    v_lshlrev_b32 v110, 16, v18
    v_mul_f32 v104, v110, v104
    v_mul_f32 v105, v110, v105
    v_mul_f32 v20, 0x3fb8aa3b, v104
    v_mul_f32 v21, 0.15915494, v105
    s_cmp_eq_u32 s33, 0
    s_cbranch_scc0 L_rows1
    v_mul_f32 v22, 0x41000000, v20
    v_mul_f32 v24, 0x41000000, v21
    v_exp_f32 v22, v22
    v_fract_f32 v24, v24
    v_cos_f32 v25, v24
    v_sin_f32 v24, v24
    s_nop 0
    v_mul_f32 v30, v22, v25
    v_mul_f32 v31, v22, v24
    v_mul_f32 v22, 0x41800000, v20
    v_mul_f32 v24, 0x41800000, v21
    v_exp_f32 v22, v22
    v_fract_f32 v24, v24
    v_cos_f32 v25, v24
    v_sin_f32 v24, v24
    s_nop 0
    v_mul_f32 v32, v22, v25
    v_mul_f32 v33, v22, v24
    v_mov_b32 v40, 1.0
    v_mov_b32 v41, 0
    v_cvt_pk_bf16_f32 v19, v40, v41
    ds_write_b32 v60, v19 offset:21504
    v_cvt_pk_bf16_f32 v18, v30, v31
    ds_write_b32 v61, v18 offset:22528
    v_cvt_pk_bf16_f32 v19, v32, v33
    ds_write_b32 v62, v19 offset:23552
    v_mul_f32 v22, v31, v33
    v_mul_f32 v24, v31, v32
    v_fma_f32 v48, v30, v32, -v22
    v_fma_f32 v49, v30, v33, v24
    v_cvt_pk_bf16_f32 v18, v48, v49
    ds_write_b32 v63, v18 offset:24576
    v_mul_f32 v22, v33, v33
    v_mul_f32 v24, v33, v32
    v_fma_f32 v42, v32, v32, -v22
    v_fma_f32 v43, v32, v33, v24
    v_cvt_pk_bf16_f32 v19, v42, v43
    ds_write_b32 v64, v19 offset:25600
    v_mul_f32 v22, v49, v33
    v_mul_f32 v24, v49, v32
    v_fma_f32 v46, v48, v32, -v22
    v_fma_f32 v47, v48, v33, v24
    v_cvt_pk_bf16_f32 v18, v46, v47
    ds_write_b32 v65, v18 offset:26624
    v_mul_f32 v22, v43, v33
    v_mul_f32 v24, v43, v32
    v_fma_f32 v44, v42, v32, -v22
    v_fma_f32 v45, v42, v33, v24
    v_cvt_pk_bf16_f32 v19, v44, v45
    ds_write_b32 v66, v19 offset:27648
    v_mul_f32 v22, v47, v33
    v_mul_f32 v24, v47, v32
    v_fma_f32 v48, v46, v32, -v22
    v_fma_f32 v49, v46, v33, v24
    v_cvt_pk_bf16_f32 v18, v48, v49
    ds_write_b32 v67, v18 offset:28672
    v_mul_f32 v22, v45, v33
    v_mul_f32 v24, v45, v32
    v_fma_f32 v42, v44, v32, -v22
    v_fma_f32 v43, v44, v33, v24
    v_cvt_pk_bf16_f32 v19, v42, v43
    ds_write_b32 v60, v19 offset:29696
    v_mul_f32 v22, v49, v33
    v_mul_f32 v24, v49, v32
    v_fma_f32 v46, v48, v32, -v22
    v_fma_f32 v47, v48, v33, v24
    v_cvt_pk_bf16_f32 v18, v46, v47
    ds_write_b32 v61, v18 offset:30720
    v_mul_f32 v22, v43, v33
    v_mul_f32 v24, v43, v32
    v_fma_f32 v44, v42, v32, -v22
    v_fma_f32 v45, v42, v33, v24
    v_cvt_pk_bf16_f32 v19, v44, v45
    ds_write_b32 v62, v19 offset:31744
    v_mul_f32 v22, v47, v33
    v_mul_f32 v24, v47, v32
    v_fma_f32 v48, v46, v32, -v22
    v_fma_f32 v49, v46, v33, v24
    v_cvt_pk_bf16_f32 v18, v48, v49
    ds_write_b32 v63, v18 offset:32768
    v_mul_f32 v22, v45, v33
    v_mul_f32 v24, v45, v32
    v_fma_f32 v42, v44, v32, -v22
    v_fma_f32 v43, v44, v33, v24
    v_cvt_pk_bf16_f32 v19, v42, v43
    ds_write_b32 v64, v19 offset:33792
    v_mul_f32 v22, v49, v33
    v_mul_f32 v24, v49, v32
    v_fma_f32 v46, v48, v32, -v22
    v_fma_f32 v47, v48, v33, v24
    v_cvt_pk_bf16_f32 v18, v46, v47
    ds_write_b32 v65, v18 offset:34816
    v_mul_f32 v22, v43, v33
    v_mul_f32 v24, v43, v32
    v_fma_f32 v44, v42, v32, -v22
    v_fma_f32 v45, v42, v33, v24
    v_cvt_pk_bf16_f32 v19, v44, v45
    ds_write_b32 v66, v19 offset:35840
    v_mul_f32 v22, v47, v33
    v_mul_f32 v24, v47, v32
    v_fma_f32 v48, v46, v32, -v22
    v_fma_f32 v49, v46, v33, v24
    v_cvt_pk_bf16_f32 v18, v48, v49
    ds_write_b32 v67, v18 offset:36864
    v_mul_f32 v22, v45, v33
    v_mul_f32 v24, v45, v32
    v_fma_f32 v42, v44, v32, -v22
    v_fma_f32 v43, v44, v33, v24
    v_cvt_pk_bf16_f32 v19, v42, v43
    ds_write_b32 v60, v19 offset:37888
    v_mul_f32 v22, v49, v33
    v_mul_f32 v24, v49, v32
    v_fma_f32 v46, v48, v32, -v22
    v_fma_f32 v47, v48, v33, v24
    v_cvt_pk_bf16_f32 v18, v46, v47
    ds_write_b32 v61, v18 offset:38912
    v_mul_f32 v22, v43, v33
    v_mul_f32 v24, v43, v32
    v_fma_f32 v44, v42, v32, -v22
    v_fma_f32 v45, v42, v33, v24
    v_cvt_pk_bf16_f32 v19, v44, v45
    ds_write_b32 v62, v19 offset:39936
    v_mul_f32 v22, v47, v33
    v_mul_f32 v24, v47, v32
    v_fma_f32 v48, v46, v32, -v22
    v_fma_f32 v49, v46, v33, v24
    v_cvt_pk_bf16_f32 v18, v48, v49
    ds_write_b32 v63, v18 offset:40960
    v_mul_f32 v22, v45, v33
    v_mul_f32 v24, v45, v32
    v_fma_f32 v42, v44, v32, -v22
    v_fma_f32 v43, v44, v33, v24
    v_cvt_pk_bf16_f32 v19, v42, v43
    ds_write_b32 v64, v19 offset:41984
    v_mul_f32 v22, v49, v33
    v_mul_f32 v24, v49, v32
    v_fma_f32 v46, v48, v32, -v22
    v_fma_f32 v47, v48, v33, v24
    v_cvt_pk_bf16_f32 v18, v46, v47
    ds_write_b32 v65, v18 offset:43008
    v_mul_f32 v22, v43, v33
    v_mul_f32 v24, v43, v32
    v_fma_f32 v44, v42, v32, -v22
    v_fma_f32 v45, v42, v33, v24
    v_cvt_pk_bf16_f32 v19, v44, v45
    ds_write_b32 v66, v19 offset:44032
    v_mul_f32 v22, v47, v33
    v_mul_f32 v24, v47, v32
    v_fma_f32 v48, v46, v32, -v22
    v_fma_f32 v49, v46, v33, v24
    v_cvt_pk_bf16_f32 v18, v48, v49
    ds_write_b32 v67, v18 offset:45056
    v_mul_f32 v22, v45, v33
    v_mul_f32 v24, v45, v32
    v_fma_f32 v42, v44, v32, -v22
    v_fma_f32 v43, v44, v33, v24
    v_cvt_pk_bf16_f32 v19, v42, v43
    ds_write_b32 v60, v19 offset:46080
    v_mul_f32 v22, v49, v33
    v_mul_f32 v24, v49, v32
    v_fma_f32 v46, v48, v32, -v22
    v_fma_f32 v47, v48, v33, v24
    v_cvt_pk_bf16_f32 v18, v46, v47
    ds_write_b32 v61, v18 offset:47104
    v_mul_f32 v22, v43, v33
    v_mul_f32 v24, v43, v32
    v_fma_f32 v44, v42, v32, -v22
    v_fma_f32 v45, v42, v33, v24
    v_cvt_pk_bf16_f32 v19, v44, v45
    ds_write_b32 v62, v19 offset:48128
    v_mul_f32 v22, v47, v33
    v_mul_f32 v24, v47, v32
    v_fma_f32 v48, v46, v32, -v22
    v_fma_f32 v49, v46, v33, v24
    v_cvt_pk_bf16_f32 v18, v48, v49
    ds_write_b32 v63, v18 offset:49152
    v_mul_f32 v22, v45, v33
    v_mul_f32 v24, v45, v32
    v_fma_f32 v42, v44, v32, -v22
    v_fma_f32 v43, v44, v33, v24
    v_cvt_pk_bf16_f32 v19, v42, v43
    ds_write_b32 v64, v19 offset:50176
    v_mul_f32 v22, v49, v33
    v_mul_f32 v24, v49, v32
    v_fma_f32 v46, v48, v32, -v22
    v_fma_f32 v47, v48, v33, v24
    v_cvt_pk_bf16_f32 v18, v46, v47
    ds_write_b32 v65, v18 offset:51200
    v_mul_f32 v22, v43, v33
    v_mul_f32 v24, v43, v32
    v_fma_f32 v44, v42, v32, -v22
    v_fma_f32 v45, v42, v33, v24
    v_cvt_pk_bf16_f32 v19, v44, v45
    ds_write_b32 v66, v19 offset:52224
    v_mul_f32 v22, v47, v33
    v_mul_f32 v24, v47, v32
    v_fma_f32 v48, v46, v32, -v22
    v_fma_f32 v49, v46, v33, v24
    v_cvt_pk_bf16_f32 v18, v48, v49
    ds_write_b32 v67, v18 offset:53248
    s_branch L_tab1
L_rows1:
    v_lshlrev_b32 v106, 16, v106
    v_lshlrev_b32 v107, 16, v107
    v_lshlrev_b32 v108, 16, v108
    v_lshlrev_b32 v109, 16, v109
    v_mul_f32 v106, v110, v106
    v_mul_f32 v107, v110, v107
    v_mul_f32 v22, v109, v107
    v_mul_f32 v24, v109, v106
    v_fma_f32 v26, v108, v106, -v22
    v_fma_f32 v27, v108, v107, v24
    v_mul_f32 v22, 0x3f800000, v20
    v_mul_f32 v24, 0x3f800000, v21
    v_exp_f32 v22, v22
    v_fract_f32 v24, v24
    v_cos_f32 v25, v24
    v_sin_f32 v24, v24
    s_nop 0
    v_mul_f32 v28, v22, v25
    v_mul_f32 v29, v22, v24
    v_mul_f32 v22, 0x43800000, v20
    v_mul_f32 v24, 0x43800000, v21
    v_exp_f32 v22, v22
    v_fract_f32 v24, v24
    v_cos_f32 v25, v24
    v_sin_f32 v24, v24
    s_nop 0
    v_mul_f32 v32, v22, v25
    v_mul_f32 v33, v22, v24
    v_mul_f32 v22, 0x44800000, v20
    v_mul_f32 v24, 0x44800000, v21
    v_exp_f32 v22, v22
    v_fract_f32 v24, v24
    v_cos_f32 v25, v24
    v_sin_f32 v24, v24
    s_nop 0
    v_mul_f32 v34, v22, v25
    v_mul_f32 v35, v22, v24
    v_cvt_pk_bf16_f32 v19, v26, -v27
    ds_write_b32 v60, v19 offset:0
    v_mul_f32 v22, v27, v29
    v_mul_f32 v24, v27, v28
    v_fma_f32 v44, v26, v28, -v22
    v_fma_f32 v45, v26, v29, v24
    v_cvt_pk_bf16_f32 v18, v44, -v45
    ds_write_b32 v61, v18 offset:1024
    v_mul_f32 v22, v45, v29
    v_mul_f32 v24, v45, v28
    v_fma_f32 v46, v44, v28, -v22
    v_fma_f32 v47, v44, v29, v24
    v_cvt_pk_bf16_f32 v19, v46, -v47
    ds_write_b32 v62, v19 offset:2048
    v_mul_f32 v22, v47, v29
    v_mul_f32 v24, v47, v28
    v_fma_f32 v44, v46, v28, -v22
    v_fma_f32 v45, v46, v29, v24
    v_cvt_pk_bf16_f32 v18, v44, -v45
    ds_write_b32 v63, v18 offset:3072
    v_mul_f32 v22, v45, v29
    v_mul_f32 v24, v45, v28
    v_fma_f32 v48, v44, v28, -v22
    v_fma_f32 v49, v44, v29, v24
    v_cvt_pk_bf16_f32 v19, v48, -v49
    ds_write_b32 v64, v19 offset:4096
    v_mul_f32 v22, v49, v29
    v_mul_f32 v24, v49, v28
    v_fma_f32 v44, v48, v28, -v22
    v_fma_f32 v45, v48, v29, v24
    v_cvt_pk_bf16_f32 v18, v44, -v45
    ds_write_b32 v65, v18 offset:5120
    v_mul_f32 v22, v45, v29
    v_mul_f32 v24, v45, v28
    v_fma_f32 v50, v44, v28, -v22
    v_fma_f32 v51, v44, v29, v24
    v_cvt_pk_bf16_f32 v19, v50, -v51
    ds_write_b32 v66, v19 offset:6144
    v_mul_f32 v22, v51, v29
    v_mul_f32 v24, v51, v28
    v_fma_f32 v44, v50, v28, -v22
    v_fma_f32 v45, v50, v29, v24
    v_cvt_pk_bf16_f32 v18, v44, -v45
    ds_write_b32 v67, v18 offset:7168
    v_mul_f32 v22, v33, v33
    v_mul_f32 v24, v33, v32
    v_fma_f32 v36, v32, v32, -v22
    v_fma_f32 v37, v32, v33, v24
    v_mul_f32 v22, v37, v33
    v_mul_f32 v24, v37, v32
    v_fma_f32 v38, v36, v32, -v22
    v_fma_f32 v39, v36, v33, v24
    v_mul_f32 v22, v27, v33
    v_mul_f32 v24, v27, v32
    v_fma_f32 v42, v26, v32, -v22
    v_fma_f32 v43, v26, v33, v24
    v_cvt_pk_bf16_f32 v19, v42, -v43
    ds_write_b32 v60, v19 offset:8192
    v_mul_f32 v22, v47, v33
    v_mul_f32 v24, v47, v32
    v_fma_f32 v44, v46, v32, -v22
    v_fma_f32 v45, v46, v33, v24
    v_cvt_pk_bf16_f32 v18, v44, -v45
    ds_write_b32 v61, v18 offset:9216
    v_mul_f32 v22, v49, v33
    v_mul_f32 v24, v49, v32
    v_fma_f32 v42, v48, v32, -v22
    v_fma_f32 v43, v48, v33, v24
    v_cvt_pk_bf16_f32 v19, v42, -v43
    ds_write_b32 v62, v19 offset:10240
    v_mul_f32 v22, v51, v33
    v_mul_f32 v24, v51, v32
    v_fma_f32 v44, v50, v32, -v22
    v_fma_f32 v45, v50, v33, v24
    v_cvt_pk_bf16_f32 v18, v44, -v45
    ds_write_b32 v63, v18 offset:11264
    v_mul_f32 v22, v27, v37
    v_mul_f32 v24, v27, v36
    v_fma_f32 v42, v26, v36, -v22
    v_fma_f32 v43, v26, v37, v24
    v_cvt_pk_bf16_f32 v19, v42, -v43
    ds_write_b32 v64, v19 offset:12288
    v_mul_f32 v22, v49, v37
    v_mul_f32 v24, v49, v36
    v_fma_f32 v44, v48, v36, -v22
    v_fma_f32 v45, v48, v37, v24
    v_cvt_pk_bf16_f32 v18, v44, -v45
    ds_write_b32 v65, v18 offset:13312
    v_mul_f32 v22, v27, v39
    v_mul_f32 v24, v27, v38
    v_fma_f32 v42, v26, v38, -v22
    v_fma_f32 v43, v26, v39, v24
    v_cvt_pk_bf16_f32 v19, v42, -v43
    ds_write_b32 v66, v19 offset:14336
    v_mul_f32 v22, v49, v39
    v_mul_f32 v24, v49, v38
    v_fma_f32 v44, v48, v38, -v22
    v_fma_f32 v45, v48, v39, v24
    v_cvt_pk_bf16_f32 v18, v44, -v45
    ds_write_b32 v67, v18 offset:15360
    v_mul_f32 v22, v27, v35
    v_mul_f32 v24, v27, v34
    v_fma_f32 v52, v26, v34, -v22
    v_fma_f32 v53, v26, v35, v24
    v_cvt_pk_bf16_f32 v19, v52, -v53
    ds_write_b32 v60, v19 offset:16384
    v_mul_f32 v22, v53, v33
    v_mul_f32 v24, v53, v32
    v_fma_f32 v42, v52, v32, -v22
    v_fma_f32 v43, v52, v33, v24
    v_cvt_pk_bf16_f32 v18, v42, -v43
    ds_write_b32 v61, v18 offset:17408
    v_mul_f32 v22, v53, v37
    v_mul_f32 v24, v53, v36
    v_fma_f32 v44, v52, v36, -v22
    v_fma_f32 v45, v52, v37, v24
    v_cvt_pk_bf16_f32 v19, v44, -v45
    ds_write_b32 v62, v19 offset:18432
    v_mul_f32 v22, v53, v39
    v_mul_f32 v24, v53, v38
    v_fma_f32 v42, v52, v38, -v22
    v_fma_f32 v43, v52, v39, v24
    v_cvt_pk_bf16_f32 v18, v42, -v43
    ds_write_b32 v63, v18 offset:19456
    v_mul_f32 v22, v53, v35
    v_mul_f32 v24, v53, v34
    v_fma_f32 v44, v52, v34, -v22
    v_fma_f32 v45, v52, v35, v24
    v_cvt_pk_bf16_f32 v19, v44, -v45
    ds_write_b32 v64, v19 offset:20480
L_tab1:
    s_waitcnt lgkmcnt(0)
    s_barrier
    s_cmp_eq_u32 s33, 0
    s_cbranch_scc0 L_nomm1
    ds_read_b128 v[26:29], v70 offset:0
    ds_read_b128 v[30:33], v74 offset:0
    ds_read_b128 v[34:37], v71 offset:0
    ds_read_b128 v[38:41], v75 offset:0
    ds_read_b128 v[42:45], v72 offset:0
    ds_read_b128 v[46:49], v76 offset:0
    ds_read_b128 v[50:53], v73 offset:0
    ds_read_b128 v[54:57], v77 offset:0
    s_waitcnt lgkmcnt(6)
    v_mfma_f32_16x16x32_bf16 v[12:15], v[26:29], v[30:33], 0
    ds_read_b128 v[26:29], v70 offset:256
    ds_read_b128 v[30:33], v74 offset:256
    s_waitcnt lgkmcnt(6)
    v_mfma_f32_16x16x32_bf16 v[12:15], v[34:37], v[38:41], v[12:15]
    ds_read_b128 v[34:37], v71 offset:256
    ds_read_b128 v[38:41], v75 offset:256
    s_waitcnt lgkmcnt(6)
    v_mfma_f32_16x16x32_bf16 v[12:15], v[42:45], v[46:49], v[12:15]
    ds_read_b128 v[42:45], v72 offset:256
    ds_read_b128 v[46:49], v76 offset:256
    s_waitcnt lgkmcnt(6)
    v_mfma_f32_16x16x32_bf16 v[12:15], v[50:53], v[54:57], v[12:15]
    ds_read_b128 v[50:53], v73 offset:256
    ds_read_b128 v[54:57], v77 offset:256
    s_waitcnt lgkmcnt(6)
    v_mfma_f32_16x16x32_bf16 v[12:15], v[26:29], v[30:33], v[12:15]
    ds_read_b128 v[26:29], v70 offset:512
    ds_read_b128 v[30:33], v74 offset:512
    s_waitcnt lgkmcnt(6)
    v_mfma_f32_16x16x32_bf16 v[12:15], v[34:37], v[38:41], v[12:15]
    ds_read_b128 v[34:37], v71 offset:512
    ds_read_b128 v[38:41], v75 offset:512
    s_waitcnt lgkmcnt(6)
    v_mfma_f32_16x16x32_bf16 v[12:15], v[42:45], v[46:49], v[12:15]
    ds_read_b128 v[42:45], v72 offset:512
    ds_read_b128 v[46:49], v76 offset:512
    s_waitcnt lgkmcnt(6)
    v_mfma_f32_16x16x32_bf16 v[12:15], v[50:53], v[54:57], v[12:15]
    ds_read_b128 v[50:53], v73 offset:512
    ds_read_b128 v[54:57], v77 offset:512
    s_waitcnt lgkmcnt(6)
    v_mfma_f32_16x16x32_bf16 v[12:15], v[26:29], v[30:33], v[12:15]
    ds_read_b128 v[26:29], v70 offset:768
    ds_read_b128 v[30:33], v74 offset:768
    s_waitcnt lgkmcnt(6)
    v_mfma_f32_16x16x32_bf16 v[12:15], v[34:37], v[38:41], v[12:15]
    ds_read_b128 v[34:37], v71 offset:768
    ds_read_b128 v[38:41], v75 offset:768
    s_waitcnt lgkmcnt(6)
    v_mfma_f32_16x16x32_bf16 v[12:15], v[42:45], v[46:49], v[12:15]
    ds_read_b128 v[42:45], v72 offset:768
    ds_read_b128 v[46:49], v76 offset:768
    s_waitcnt lgkmcnt(6)
    v_mfma_f32_16x16x32_bf16 v[12:15], v[50:53], v[54:57], v[12:15]
    ds_read_b128 v[50:53], v73 offset:768
    ds_read_b128 v[54:57], v77 offset:768
    s_waitcnt lgkmcnt(6)
    v_mfma_f32_16x16x32_bf16 v[12:15], v[26:29], v[30:33], v[12:15]
    s_waitcnt lgkmcnt(4)
    v_mfma_f32_16x16x32_bf16 v[12:15], v[34:37], v[38:41], v[12:15]
    s_waitcnt lgkmcnt(2)
    v_mfma_f32_16x16x32_bf16 v[12:15], v[42:45], v[46:49], v[12:15]
    s_waitcnt lgkmcnt(0)
    v_mfma_f32_16x16x32_bf16 v[12:15], v[50:53], v[54:57], v[12:15]
    s_nop 7
    v_cvt_pk_bf16_f32 v16, v12, v13
    v_cvt_pk_bf16_f32 v17, v14, v15
    ds_write_b16 v80, v16 offset:59392
    ds_write_b16_d16_hi v81, v16 offset:59392
    ds_write_b16 v82, v17 offset:59392
    ds_write_b16_d16_hi v83, v17 offset:59392
    s_waitcnt lgkmcnt(0)
    s_branch L_nomm1b
L_nomm1:
L_nomm1b:
    s_barrier
    s_mul_i32 s34, s33, 33280
    s_mul_i32 s35, s33, 7600
    s_add_u32 s35, s35, 66560
    s_mul_i32 s36, s33, 5120
    s_add_u32 s36, s36, 54272
    v_lshlrev_b32 v3, 3, v23
    v_add_u32 v26, -7, v3
    v_max_i32 v26, 0, v26
    v_cvt_f32_u32 v26, v26
    v_add_u32 v27, -6, v3
    v_max_i32 v27, 0, v27
    v_cvt_f32_u32 v27, v27
    v_add_u32 v28, -5, v3
    v_max_i32 v28, 0, v28
    v_cvt_f32_u32 v28, v28
    v_add_u32 v29, -4, v3
    v_max_i32 v29, 0, v29
    v_cvt_f32_u32 v29, v29
    v_add_u32 v30, -3, v3
    v_max_i32 v30, 0, v30
    v_cvt_f32_u32 v30, v30
    v_add_u32 v31, -2, v3
    v_max_i32 v31, 0, v31
    v_cvt_f32_u32 v31, v31
    v_add_u32 v32, -1, v3
    v_max_i32 v32, 0, v32
    v_cvt_f32_u32 v32, v32
    v_add_u32 v33, 0, v3
    v_max_i32 v33, 0, v33
    v_cvt_f32_u32 v33, v33
    v_add_u32 v34, 1, v3
    v_max_i32 v34, 0, v34
    v_cvt_f32_u32 v34, v34
    v_add_u32 v35, 2, v3
    v_max_i32 v35, 0, v35
    v_cvt_f32_u32 v35, v35
    v_add_u32 v36, 3, v3
    v_max_i32 v36, 0, v36
    v_cvt_f32_u32 v36, v36
    v_add_u32 v37, 4, v3
    v_max_i32 v37, 0, v37
    v_cvt_f32_u32 v37, v37
    v_add_u32 v38, 5, v3
    v_max_i32 v38, 0, v38
    v_cvt_f32_u32 v38, v38
    v_add_u32 v39, 6, v3
    v_max_i32 v39, 0, v39
    v_cvt_f32_u32 v39, v39
    v_add_u32 v40, 7, v3
    v_max_i32 v40, 0, v40
    v_cvt_f32_u32 v40, v40
    v_cvt_pk_bf16_f32 v18, v26, v27
    v_lshlrev_b32 v26, 16, v18
    v_and_b32 v27, 0xffff0000, v18
    v_cvt_pk_bf16_f32 v18, v28, v29
    v_lshlrev_b32 v28, 16, v18
    v_and_b32 v29, 0xffff0000, v18
    v_cvt_pk_bf16_f32 v18, v30, v31
    v_lshlrev_b32 v30, 16, v18
    v_and_b32 v31, 0xffff0000, v18
    v_cvt_pk_bf16_f32 v18, v32, v33
    v_lshlrev_b32 v32, 16, v18
    v_and_b32 v33, 0xffff0000, v18
    v_cvt_pk_bf16_f32 v18, v34, v35
    v_lshlrev_b32 v34, 16, v18
    v_and_b32 v35, 0xffff0000, v18
    v_cvt_pk_bf16_f32 v18, v36, v37
    v_lshlrev_b32 v36, 16, v18
    v_and_b32 v37, 0xffff0000, v18
    v_cvt_pk_bf16_f32 v18, v38, v39
    v_lshlrev_b32 v38, 16, v18
    v_and_b32 v39, 0xffff0000, v18
    v_cvt_pk_bf16_f32 v18, v40, v40
    v_lshlrev_b32 v40, 16, v18
    v_cvt_u32_f32 v26, v26
    v_lshl_add_u32 v26, v26, 1, s36
    v_cvt_u32_f32 v27, v27
    v_lshl_add_u32 v27, v27, 1, s36
    v_cvt_u32_f32 v28, v28
    v_lshl_add_u32 v28, v28, 1, s36
    v_cvt_u32_f32 v29, v29
    v_lshl_add_u32 v29, v29, 1, s36
    v_cvt_u32_f32 v30, v30
    v_lshl_add_u32 v30, v30, 1, s36
    v_cvt_u32_f32 v31, v31
    v_lshl_add_u32 v31, v31, 1, s36
    v_cvt_u32_f32 v32, v32
    v_lshl_add_u32 v32, v32, 1, s36
    v_cvt_u32_f32 v33, v33
    v_lshl_add_u32 v33, v33, 1, s36
    v_cvt_u32_f32 v34, v34
    v_lshl_add_u32 v34, v34, 1, s36
    v_cvt_u32_f32 v35, v35
    v_lshl_add_u32 v35, v35, 1, s36
    v_cvt_u32_f32 v36, v36
    v_lshl_add_u32 v36, v36, 1, s36
    v_cvt_u32_f32 v37, v37
    v_lshl_add_u32 v37, v37, 1, s36
    v_cvt_u32_f32 v38, v38
    v_lshl_add_u32 v38, v38, 1, s36
    v_cvt_u32_f32 v39, v39
    v_lshl_add_u32 v39, v39, 1, s36
    v_cvt_u32_f32 v40, v40
    v_lshl_add_u32 v40, v40, 1, s36
    ds_read_u16 v42, v26
    ds_read_u16 v43, v27
    ds_read_u16 v44, v28
    ds_read_u16 v45, v29
    ds_read_u16 v46, v30
    ds_read_u16 v47, v31
    ds_read_u16 v48, v32
    ds_read_u16 v49, v33
    ds_read_u16 v50, v34
    ds_read_u16 v51, v35
    ds_read_u16 v52, v36
    ds_read_u16 v53, v37
    ds_read_u16 v54, v38
    ds_read_u16 v55, v39
    ds_read_u16 v56, v40
    s_add_u32 s24, s3, s33
    v_bfe_u32 v1, v0, 6, 2
    v_and_b32 v2, 63, v0
    v_lshlrev_b32 v3, 4, v2
    v_lshlrev_b32 v6, 4, v23
    v_add3_u32 v7, v6, 48, s34
    v_lshrrev_b32 v8, 3, v0
    v_mul_u32_u24 v8, 80, v8
    v_bfe_u32 v9, v0, 2, 1
    v_lshl_add_u32 v8, v9, 5, v8
    v_and_b32 v9, 1, v0
    v_lshl_add_u32 v8, v9, 4, v8
    v_bfe_u32 v9, v0, 1, 1
    v_mul_u32_u24 v9, 7600, v9
    v_add_u32 v8, 66560, v8
    v_add_u32 v8, v8, v9
    v_lshrrev_b32 v100, 2, v0
    v_mul_u32_u24 v100, 14336, v100
    v_and_b32 v9, 3, v0
    v_lshl_add_u32 v100, v9, 4, v100
    s_lshl_b32 s43, s3, 5
    s_mov_b32 s8, s18
    s_mov_b32 s9, s19
    s_mov_b32 s10, 0x380
    s_mov_b32 s11, 0x00020000
    s_add_u32 s16, s22, 0x200000
    s_addc_u32 s17, s23, 0
    s_mov_b32 s18, 0x1c0000
    s_mov_b32 s19, 0x00020000
    s_add_u32 s28, s22, 0x1000000
    s_addc_u32 s29, s23, 0
    s_mov_b32 s30, 0x1ce000
    s_mov_b32 s31, 0x00020000
    s_mul_i32 s25, s24, 4224
    s_lshl_b32 s27, s24, 1
    v_mov_b32 v5, 0
    buffer_load_ushort v22, v5, s[8:11], s27 offen
    v_cmp_eq_u32 vcc, 0, v23
    s_waitcnt lgkmcnt(0)
    v_cndmask_b32 v42, v42, 0, vcc
    v_cndmask_b32 v43, v43, 0, vcc
    v_cndmask_b32 v44, v44, 0, vcc
    v_cndmask_b32 v45, v45, 0, vcc
    v_cndmask_b32 v46, v46, 0, vcc
    v_cndmask_b32 v47, v47, 0, vcc
    v_cndmask_b32 v48, v48, 0, vcc
    v_lshl_or_b32 v64, v43, 16, v42
    v_lshl_or_b32 v72, v45, 16, v44
    v_lshl_or_b32 v80, v44, 16, v43
    v_lshl_or_b32 v88, v46, 16, v45
    v_lshl_or_b32 v65, v45, 16, v44
    v_lshl_or_b32 v73, v47, 16, v46
    v_lshl_or_b32 v81, v46, 16, v45
    v_lshl_or_b32 v89, v48, 16, v47
    v_lshl_or_b32 v66, v47, 16, v46
    v_lshl_or_b32 v74, v49, 16, v48
    v_lshl_or_b32 v82, v48, 16, v47
    v_lshl_or_b32 v90, v50, 16, v49
    v_lshl_or_b32 v67, v49, 16, v48
    v_lshl_or_b32 v75, v51, 16, v50
    v_lshl_or_b32 v83, v50, 16, v49
    v_lshl_or_b32 v91, v52, 16, v51
    v_lshl_or_b32 v68, v51, 16, v50
    v_lshl_or_b32 v76, v53, 16, v52
    v_lshl_or_b32 v84, v52, 16, v51
    v_lshl_or_b32 v92, v54, 16, v53
    v_lshl_or_b32 v69, v53, 16, v52
    v_lshl_or_b32 v77, v55, 16, v54
    v_lshl_or_b32 v85, v54, 16, v53
    v_lshl_or_b32 v93, v56, 16, v55
    s_mov_b32 s42, 0
    s_cmp_lg_u32 s26, 0
    s_cbranch_scc1 L_w8_d
    s_mov_b64 exec, 0xffff
    v_lshlrev_b32 v126, 8, v0
    v_mov_b32 v124, 0
    s_mov_b32 s49, 0
    s_cmp_eq_u32 s98, 1
    s_cbranch_scc1 L_w8
L_w8_i:
    buffer_load_dword v125, v124, s[52:55], 0 offen offset:128 sc1
    s_add_u32 s49, s49, 1
    s_waitcnt vmcnt(0)
    v_readfirstlane_b32 s98, v125
    s_cmp_eq_u32 s98, 1
    s_cbranch_scc1 L_w8
    s_cmp_gt_u32 s49, 262144
    s_cbranch_scc1 L_w8
    s_sleep 2
    s_branch L_w8_i
L_w8:
    buffer_load_dword v127, v126, s[84:87], s42 offen offset:0 sc1
    s_add_u32 s49, s49, 1
    s_waitcnt vmcnt(0)
    v_cmp_ne_u32 vcc, 8, v127
    s_cmp_gt_u32 s49, 262144
    s_cbranch_scc1 L_w8_x
    s_cbranch_vccz L_w8_x
    s_sleep 8
    s_branch L_w8
L_w8_x:
    s_mov_b64 exec, -1
L_w8_d:
    s_barrier
    buffer_load_dwordx4 v[96:99], v100, s[16:19], s43 offen
    ds_write_b128 v7, v[64:67] offset:0
    ds_write_b128 v7, v[80:83] offset:4160
    ds_write_b128 v7, v[72:75] offset:8320
    ds_write_b128 v7, v[88:91] offset:12480
    ds_write_b128 v7, v[66:69] offset:16640
    ds_write_b128 v7, v[82:85] offset:20800
    ds_write_b128 v7, v[74:77] offset:24960
    ds_write_b128 v7, v[90:93] offset:29120
    v_mov_b32 v12, 0
    v_mov_b32 v13, 0
    v_mov_b32 v14, 0
    v_mov_b32 v15, 0
    v_lshrrev_b32 v10, 2, v23
    v_mul_u32_u24 v10, 4160, v10
    v_lshl_add_u32 v10, v9, 4, v10
    v_add_u32 v10, s34, v10
    v_cmp_gt_u32 vcc, 32, v23
    v_cmp_gt_u32 s[40:41], 3, v9
    s_and_b64 vcc, vcc, s[40:41]
    s_and_saveexec_b64 s[40:41], vcc
    ds_write_b128 v10, v[12:15]
    s_mov_b64 exec, s[40:41]
    v_add_u32 v10, 5120, v6
    v_add_u32 v10, s35, v10
    v_cmp_gt_u32 vcc, 155, v23
    s_and_saveexec_b64 s[40:41], vcc
    ds_write_b128 v10, v[12:15]
    s_mov_b64 exec, s[40:41]
    v_and_b32 v10, 31, v0
    v_bfe_u32 v11, v0, 5, 1
    v_and_b32 v12, 7, v10
    v_mul_u32_u24 v12, 4160, v12
    v_lshrrev_b32 v13, 3, v10
    v_add_u32 v13, v13, v11
    v_lshl_add_u32 v12, v13, 4, v12
    v_lshl_add_u32 v16, v1, 9, v12
    v_add_u32 v16, s34, v16
    v_sub_u32 v12, 31, v10
    v_mul_u32_u24 v12, 80, v12
    v_mul_u32_u24 v13, 640, v1
    v_lshl_add_u32 v13, v11, 4, v13
    v_add3_u32 v17, v12, v13, s35
    v_lshrrev_b32 v13, 1, v1
    v_sub_u32 v13, 1, v13
    v_mul_u32_u24 v13, 2560, v13
    v_add_u32 v13, v13, v12
    v_and_b32 v14, 1, v1
    v_lshlrev_b32 v15, 5, v14
    v_lshl_add_u32 v15, v11, 3, v15
    v_sub_u32 v13, v13, v15
    v_add3_u32 v18, v13, 40, s35
    v_lshlrev_b32 v19, 13, v1
    v_add3_u32 v19, v19, v3, s34
    v_lshlrev_b32 v20, 11, v1
    v_add3_u32 v20, v20, v3, s34
    v_lshrrev_b32 v13, 1, v1
    v_lshlrev_b32 v13, 11, v13
    v_lshl_add_u32 v13, v10, 6, v13
    v_add_u32 v21, v13, v15
    v_lshl_add_u32 v21, v11, 3, v21
    s_waitcnt vmcnt(0)
    ds_write_b128 v8, v[96:99]
    v_lshlrev_b32 v22, 16, v22
    s_waitcnt lgkmcnt(0)
    s_barrier
    ds_read_b64 v[24:25], v18 offset:16
    ds_read_b64 v[26:27], v18
    ds_read_b128 v[64:67], v16 offset:0
    ds_read_b128 v[68:71], v17 offset:2560
    ds_read_b128 v[72:75], v17 offset:0
    ds_read_b128 v[76:79], v16 offset:2048
    ds_read_b128 v[80:83], v16 offset:32
    ds_read_b128 v[84:87], v17 offset:2592
    ds_read_b128 v[88:91], v17 offset:32
    ds_read_b128 v[92:95], v16 offset:2080
    ds_read_b128 v[96:99], v16 offset:64
    ds_read_b128 v[100:103], v17 offset:2640
    ds_read_b128 v[104:107], v17 offset:80
    ds_read_b128 v[108:111], v16 offset:2112
    s_waitcnt lgkmcnt(8)
    v_mfma_f32_32x32x16_bf16 v[32:47], v[64:67], v[68:71], 0
    v_mfma_f32_32x32x16_bf16 v[48:63], v[64:67], v[72:75], 0
    v_mfma_f32_32x32x16_bf16 v[48:63], v[76:79], v[68:71], v[48:63]
    ds_read_b128 v[64:67], v16 offset:96
    ds_read_b128 v[68:71], v17 offset:2672
    ds_read_b128 v[72:75], v17 offset:112
    ds_read_b128 v[76:79], v16 offset:2144
    s_waitcnt lgkmcnt(8)
    v_mfma_f32_32x32x16_bf16 v[32:47], v[80:83], v[84:87], v[32:47]
    v_mfma_f32_32x32x16_bf16 v[48:63], v[80:83], v[88:91], v[48:63]
    v_mfma_f32_32x32x16_bf16 v[48:63], v[92:95], v[84:87], v[48:63]
    ds_read_b128 v[80:83], v16 offset:128
    ds_read_b128 v[84:87], v17 offset:2720
    ds_read_b128 v[88:91], v17 offset:160
    ds_read_b128 v[92:95], v16 offset:2176
    s_waitcnt lgkmcnt(8)
    v_mfma_f32_32x32x16_bf16 v[32:47], v[96:99], v[100:103], v[32:47]
    v_mfma_f32_32x32x16_bf16 v[48:63], v[96:99], v[104:107], v[48:63]
    v_mfma_f32_32x32x16_bf16 v[48:63], v[108:111], v[100:103], v[48:63]
    ds_read_b128 v[96:99], v16 offset:160
    ds_read_b128 v[100:103], v17 offset:2752
    ds_read_b128 v[104:107], v17 offset:192
    ds_read_b128 v[108:111], v16 offset:2208
    s_waitcnt lgkmcnt(8)
    v_mfma_f32_32x32x16_bf16 v[32:47], v[64:67], v[68:71], v[32:47]
    v_mfma_f32_32x32x16_bf16 v[48:63], v[64:67], v[72:75], v[48:63]
    v_mfma_f32_32x32x16_bf16 v[48:63], v[76:79], v[68:71], v[48:63]
    ds_read_b128 v[64:67], v16 offset:192
    ds_read_b128 v[68:71], v17 offset:2800
    ds_read_b128 v[72:75], v17 offset:240
    ds_read_b128 v[76:79], v16 offset:2240
    s_waitcnt lgkmcnt(8)
    v_mfma_f32_32x32x16_bf16 v[32:47], v[80:83], v[84:87], v[32:47]
    v_mfma_f32_32x32x16_bf16 v[48:63], v[80:83], v[88:91], v[48:63]
    v_mfma_f32_32x32x16_bf16 v[48:63], v[92:95], v[84:87], v[48:63]
    ds_read_b128 v[80:83], v16 offset:224
    ds_read_b128 v[84:87], v17 offset:2832
    ds_read_b128 v[88:91], v17 offset:272
    ds_read_b128 v[92:95], v16 offset:2272
    s_waitcnt lgkmcnt(8)
    v_mfma_f32_32x32x16_bf16 v[32:47], v[96:99], v[100:103], v[32:47]
    v_mfma_f32_32x32x16_bf16 v[48:63], v[96:99], v[104:107], v[48:63]
    v_mfma_f32_32x32x16_bf16 v[48:63], v[108:111], v[100:103], v[48:63]
    ds_read_b128 v[96:99], v16 offset:256
    ds_read_b128 v[100:103], v17 offset:2880
    ds_read_b128 v[104:107], v17 offset:320
    ds_read_b128 v[108:111], v16 offset:2304
    s_waitcnt lgkmcnt(8)
    v_mfma_f32_32x32x16_bf16 v[32:47], v[64:67], v[68:71], v[32:47]
    v_mfma_f32_32x32x16_bf16 v[48:63], v[64:67], v[72:75], v[48:63]
    v_mfma_f32_32x32x16_bf16 v[48:63], v[76:79], v[68:71], v[48:63]
    ds_read_b128 v[64:67], v16 offset:288
    ds_read_b128 v[68:71], v17 offset:2912
    ds_read_b128 v[72:75], v17 offset:352
    ds_read_b128 v[76:79], v16 offset:2336
    s_waitcnt lgkmcnt(8)
    v_mfma_f32_32x32x16_bf16 v[32:47], v[80:83], v[84:87], v[32:47]
    v_mfma_f32_32x32x16_bf16 v[48:63], v[80:83], v[88:91], v[48:63]
    v_mfma_f32_32x32x16_bf16 v[48:63], v[92:95], v[84:87], v[48:63]
    ds_read_b128 v[80:83], v16 offset:320
    ds_read_b128 v[84:87], v17 offset:2960
    ds_read_b128 v[88:91], v17 offset:400
    ds_read_b128 v[92:95], v16 offset:2368
    s_waitcnt lgkmcnt(8)
    v_mfma_f32_32x32x16_bf16 v[32:47], v[96:99], v[100:103], v[32:47]
    v_mfma_f32_32x32x16_bf16 v[48:63], v[96:99], v[104:107], v[48:63]
    v_mfma_f32_32x32x16_bf16 v[48:63], v[108:111], v[100:103], v[48:63]
    ds_read_b128 v[96:99], v16 offset:352
    ds_read_b128 v[100:103], v17 offset:2992
    ds_read_b128 v[104:107], v17 offset:432
    ds_read_b128 v[108:111], v16 offset:2400
    s_waitcnt lgkmcnt(8)
    v_mfma_f32_32x32x16_bf16 v[32:47], v[64:67], v[68:71], v[32:47]
    v_mfma_f32_32x32x16_bf16 v[48:63], v[64:67], v[72:75], v[48:63]
    v_mfma_f32_32x32x16_bf16 v[48:63], v[76:79], v[68:71], v[48:63]
    ds_read_b128 v[64:67], v16 offset:384
    ds_read_b128 v[68:71], v17 offset:3040
    ds_read_b128 v[72:75], v17 offset:480
    ds_read_b128 v[76:79], v16 offset:2432
    s_waitcnt lgkmcnt(8)
    v_mfma_f32_32x32x16_bf16 v[32:47], v[80:83], v[84:87], v[32:47]
    v_mfma_f32_32x32x16_bf16 v[48:63], v[80:83], v[88:91], v[48:63]
    v_mfma_f32_32x32x16_bf16 v[48:63], v[92:95], v[84:87], v[48:63]
    ds_read_b128 v[80:83], v16 offset:416
    ds_read_b128 v[84:87], v17 offset:3072
    ds_read_b128 v[88:91], v17 offset:512
    ds_read_b128 v[92:95], v16 offset:2464
    s_waitcnt lgkmcnt(8)
    v_mfma_f32_32x32x16_bf16 v[32:47], v[96:99], v[100:103], v[32:47]
    v_mfma_f32_32x32x16_bf16 v[48:63], v[96:99], v[104:107], v[48:63]
    v_mfma_f32_32x32x16_bf16 v[48:63], v[108:111], v[100:103], v[48:63]
    ds_read_b128 v[96:99], v16 offset:448
    ds_read_b128 v[100:103], v17 offset:3120
    ds_read_b128 v[104:107], v17 offset:560
    ds_read_b128 v[108:111], v16 offset:2496
    s_waitcnt lgkmcnt(8)
    v_mfma_f32_32x32x16_bf16 v[32:47], v[64:67], v[68:71], v[32:47]
    v_mfma_f32_32x32x16_bf16 v[48:63], v[64:67], v[72:75], v[48:63]
    v_mfma_f32_32x32x16_bf16 v[48:63], v[76:79], v[68:71], v[48:63]
    ds_read_b128 v[64:67], v16 offset:480
    ds_read_b128 v[68:71], v17 offset:3152
    ds_read_b128 v[72:75], v17 offset:592
    ds_read_b128 v[76:79], v16 offset:2528
    s_waitcnt lgkmcnt(8)
    v_mfma_f32_32x32x16_bf16 v[32:47], v[80:83], v[84:87], v[32:47]
    v_mfma_f32_32x32x16_bf16 v[48:63], v[80:83], v[88:91], v[48:63]
    v_mfma_f32_32x32x16_bf16 v[48:63], v[92:95], v[84:87], v[48:63]
    s_waitcnt lgkmcnt(4)
    v_mfma_f32_32x32x16_bf16 v[32:47], v[96:99], v[100:103], v[32:47]
    v_mfma_f32_32x32x16_bf16 v[48:63], v[96:99], v[104:107], v[48:63]
    v_mfma_f32_32x32x16_bf16 v[48:63], v[108:111], v[100:103], v[48:63]
    s_waitcnt lgkmcnt(0)
    v_mfma_f32_32x32x16_bf16 v[32:47], v[64:67], v[68:71], v[32:47]
    v_mfma_f32_32x32x16_bf16 v[48:63], v[64:67], v[72:75], v[48:63]
    v_mfma_f32_32x32x16_bf16 v[48:63], v[76:79], v[68:71], v[48:63]
    s_barrier
    s_nop 15
    ds_write_b128 v19, v[32:35] offset:0
    ds_write_b128 v19, v[36:39] offset:1024
    ds_write_b128 v19, v[40:43] offset:2048
    ds_write_b128 v19, v[44:47] offset:3072
    ds_write_b128 v19, v[48:51] offset:4096
    ds_write_b128 v19, v[52:55] offset:5120
    ds_write_b128 v19, v[56:59] offset:6144
    ds_write_b128 v19, v[60:63] offset:7168
    s_waitcnt lgkmcnt(0)
    s_barrier
    ds_read_b128 v[64:67], v20 offset:0
    ds_read_b128 v[68:71], v20 offset:8192
    ds_read_b128 v[72:75], v20 offset:16384
    ds_read_b128 v[76:79], v20 offset:24576
    ds_read_b128 v[80:83], v20 offset:1024
    ds_read_b128 v[84:87], v20 offset:9216
    ds_read_b128 v[88:91], v20 offset:17408
    ds_read_b128 v[92:95], v20 offset:25600
    s_waitcnt lgkmcnt(4)
    v_add_f32 v64, v64, v68
    v_add_f32 v72, v72, v76
    v_add_f32 v65, v65, v69
    v_add_f32 v73, v73, v77
    v_add_f32 v66, v66, v70
    v_add_f32 v74, v74, v78
    v_add_f32 v67, v67, v71
    v_add_f32 v75, v75, v79
    v_add_f32 v64, v64, v72
    v_add_f32 v65, v65, v73
    v_add_f32 v66, v66, v74
    v_add_f32 v67, v67, v75
    v_cvt_pk_bf16_f32 v68, v64, v65
    v_cvt_pk_bf16_f32 v69, v66, v67
    v_lshlrev_b32 v64, 16, v68
    v_and_b32 v65, 0xffff0000, v68
    v_lshlrev_b32 v66, 16, v69
    v_and_b32 v67, 0xffff0000, v69
    v_and_b32 v72, 0xffff0000, v25
    v_lshlrev_b32 v73, 16, v25
    v_and_b32 v74, 0xffff0000, v24
    v_lshlrev_b32 v75, 16, v24
    v_mul_f32 v72, v72, v22
    v_mul_f32 v73, v73, v22
    v_mul_f32 v74, v74, v22
    v_mul_f32 v75, v75, v22
    v_cvt_pk_bf16_f32 v68, v72, v73
    v_cvt_pk_bf16_f32 v69, v74, v75
    v_lshlrev_b32 v72, 16, v68
    v_and_b32 v73, 0xffff0000, v68
    v_lshlrev_b32 v74, 16, v69
    v_and_b32 v75, 0xffff0000, v69
    v_add_f32 v64, v64, v72
    v_add_f32 v65, v65, v73
    v_add_f32 v66, v66, v74
    v_add_f32 v67, v67, v75
    v_cvt_pk_bf16_f32 v28, v64, v65
    v_cvt_pk_bf16_f32 v29, v66, v67
    s_waitcnt lgkmcnt(0)
    v_add_f32 v80, v80, v84
    v_add_f32 v88, v88, v92
    v_add_f32 v81, v81, v85
    v_add_f32 v89, v89, v93
    v_add_f32 v82, v82, v86
    v_add_f32 v90, v90, v94
    v_add_f32 v83, v83, v87
    v_add_f32 v91, v91, v95
    v_add_f32 v80, v80, v88
    v_add_f32 v81, v81, v89
    v_add_f32 v82, v82, v90
    v_add_f32 v83, v83, v91
    v_cvt_pk_bf16_f32 v84, v80, v81
    v_cvt_pk_bf16_f32 v85, v82, v83
    v_lshlrev_b32 v80, 16, v84
    v_and_b32 v81, 0xffff0000, v84
    v_lshlrev_b32 v82, 16, v85
    v_and_b32 v83, 0xffff0000, v85
    v_and_b32 v88, 0xffff0000, v27
    v_lshlrev_b32 v89, 16, v27
    v_and_b32 v90, 0xffff0000, v26
    v_lshlrev_b32 v91, 16, v26
    v_mul_f32 v88, v88, v22
    v_mul_f32 v89, v89, v22
    v_mul_f32 v90, v90, v22
    v_mul_f32 v91, v91, v22
    v_cvt_pk_bf16_f32 v84, v88, v89
    v_cvt_pk_bf16_f32 v85, v90, v91
    v_lshlrev_b32 v88, 16, v84
    v_and_b32 v89, 0xffff0000, v84
    v_lshlrev_b32 v90, 16, v85
    v_and_b32 v91, 0xffff0000, v85
    v_add_f32 v80, v80, v88
    v_add_f32 v81, v81, v89
    v_add_f32 v82, v82, v90
    v_add_f32 v83, v83, v91
    v_cvt_pk_bf16_f32 v30, v80, v81
    v_cvt_pk_bf16_f32 v31, v82, v83
    s_nop 1
    v_permlane32_swap_b32 v28, v30
    v_permlane32_swap_b32 v29, v31
    buffer_store_dwordx4 v[28:31], v21, s[28:31], s25 offen sc1
    s_lshr_b32 s42, s3, 6
    s_lshl_b32 s42, s42, 8
    s_add_u32 s42, s42, 8192
    s_waitcnt vmcnt(0)
    s_barrier
    s_cmp_lg_u32 s26, 0
    s_cbranch_scc1 L_sig9
    s_mov_b64 exec, 1
    v_mov_b32 v126, 0
    v_mov_b32 v127, 1
    buffer_atomic_add v127, v126, s[84:87], s42 offen offset:0 sc1
    s_mov_b64 exec, -1
L_sig9:
L_done:
    s_endpgm
.section .rodata,"a"
.p2align 6
.amdhsa_kernel main_kernel
  .amdhsa_next_free_vgpr 128
  .amdhsa_next_free_sgpr 100
  .amdhsa_accum_offset 128
  .amdhsa_group_segment_fixed_size 0
  .amdhsa_kernarg_size 136
  .amdhsa_user_sgpr_count 2
  .amdhsa_user_sgpr_kernarg_segment_ptr 1
  .amdhsa_system_sgpr_workgroup_id_x 1
.end_amdhsa_kernel
```
